```python
import torch

def _softmax(x, axis=-1):
    return torch.softmax(x, dim=axis)
def _gelu(x):
    return torch.nn.functional.gelu(x, approximate="tanh")
def _silu(x):
    return torch.nn.functional.silu(x)
def _sigmoid(x):
    return torch.sigmoid(x)
def _layernorm(x, axis=-1, eps=1e-5):
    m = x.mean(dim=axis, keepdim=True)
    v = x.var(dim=axis, keepdim=True, unbiased=False)
    return (x - m) / torch.sqrt(v + eps)
def _scatter_add(tgt, idx, src, axis=0):
    return tgt.clone().index_add_(axis, idx, src)
def _segment_sum(src, seg, n):
    out = torch.zeros((n,) + src.shape[1:], dtype=src.dtype)
    return out.index_add_(0, seg, src)
def _pad(x, pw):
    flat = tuple(v for pair in reversed(pw) for v in pair)
    return torch.nn.functional.pad(x, flat)

kernel_name = 'parallel_sum__sliding_block__dense_activation_gelu__prompt'

def setup_inputs():

    _w = (lambda a: (lambda t: t.to(torch.bfloat16) if t.is_floating_point() else t)(torch.as_tensor(a)))
    def _A_setup():
        B, S, D = 1, 2048, 448
        return {
            "x": _w((lambda *s: torch.randn(*s, dtype=torch.bfloat16) * 0.05)(B, S, D)),
            "wqkv": _w((lambda *s: torch.randn(*s, dtype=torch.bfloat16) * 0.05)(D, 3 * D)),
            "wo": _w((lambda *s: torch.randn(*s, dtype=torch.bfloat16) * 0.05)(D, D)),
        }
    _A_in = _A_setup()

    def _B_setup():
        B, S, D, F = 1, 2048, 448, 1792
        return {
            "x": _w((lambda *s: torch.randn(*s, dtype=torch.bfloat16) * 0.05)(B, S, D)),
            "w1": _w((lambda *s: torch.randn(*s, dtype=torch.bfloat16) * 0.8)(D, F) * (D ** -0.5)),
            "b1": _w((lambda *s: torch.randn(*s, dtype=torch.bfloat16) * 0.8)(F) * 0.01),
            "w2": _w((lambda *s: torch.randn(*s, dtype=torch.bfloat16) * 0.8)(F, D) * (F ** -0.5)),
            "b2": _w((lambda *s: torch.randn(*s, dtype=torch.bfloat16) * 0.8)(D) * 0.01),
        }
    _B_in = _B_setup()

    return {
        "A_x": _A_in["x"],
        "A_wqkv": _A_in["wqkv"],
        "A_wo": _A_in["wo"],
        "B_x": _B_in["x"],
        "B_w1": _B_in["w1"],
        "B_b1": _B_in["b1"],
        "B_w2": _B_in["w2"],
        "B_b2": _B_in["b2"],
    }

def reference(A_x, A_wqkv, A_wo, B_x, B_w1, B_b1, B_w2, B_b2):
    def _A_ref(x, wqkv, wo):
        B, S, D = x.shape
        H = 16; Dh = D // H; W = 256
        qkv = (lambda x, *d: x.permute(*d))((x @ wqkv).reshape(B, S, 3, H, Dh), 2, 0, 3, 1, 4)
        q, k, v = qkv[0], qkv[1], qkv[2]
        scores = torch.einsum("bhqd,bhkd->bhqk", q, k) * (Dh ** -0.5)
        idx = torch.arange(S)
        mask = (idx[:, None] - idx[None, :] >= 0) & (idx[:, None] - idx[None, :] < W)
        scores = torch.where(mask[None, None], scores, -1e9)
        p = _softmax(scores, axis=-1)
        o = torch.einsum("bhqk,bhkd->bhqd", p, v)
        return (lambda x, *d: x.permute(*d))(o, 0, 2, 1, 3).reshape(B, S, D) @ wo

    def _B_ref(x, w1, b1, w2, b2):
        h = torch.einsum("bsd,df->bsf", x, w1) + b1
        h = _gelu(h)
        return torch.einsum("bsf,fd->bsd", h, w2) + b2

    x = A_x
    xn = _layernorm(x, axis=-1)
    return x + _A_ref(xn, A_wqkv, A_wo) + _B_ref(xn, B_w1, B_b1, B_w2, B_b2)
```

```asm
; @launch grid=(256,1,1) block=(512,1,1) lds=163840
.amdgcn_target "amdgcn-amd-amdhsa--gfx950"
.text
.globl parallel_sum__sliding_block__dense_activation_gelu__prompt_kernel
.p2align 8
.type parallel_sum__sliding_block__dense_activation_gelu__prompt_kernel,@function
parallel_sum__sliding_block__dense_activation_gelu__prompt_kernel:
    s_cmp_ge_u32 s2, 256
    s_cbranch_scc1 K_exit
    s_load_dwordx16 s[64:79], s[0:1], 0
    s_load_dwordx4 s[80:83], s[0:1], 64
    s_load_dwordx2 s[84:85], s[0:1], 80
    s_getpc_b64 s[46:47]
K_pc:
    s_sub_u32 s46, s46, K_pc-parallel_sum__sliding_block__dense_activation_gelu__prompt_kernel
    s_subb_u32 s47, s47, 0
    s_bfe_u32 s45, s2, 0x30003
    s_mul_i32 s45, s45, 5120
    v_lshrrev_b32 v2, 6, v0
    v_mul_u32_u24 v2, 5, v2
    v_and_b32 v3, 63, v0
    v_add_lshl_u32 v2, v2, v3, 7
    v_add_u32 v2, s45, v2
    v_min_u32 v2, K_end-parallel_sum__sliding_block__dense_activation_gelu__prompt_kernel-4, v2
    s_mov_b64 exec, 31
    global_load_dword v95, v2, s[46:47]
    s_mov_b64 exec, -1
    v_and_b32 v1, 63, v0
    v_lshrrev_b32 v2, 6, v0
    s_and_b32 s3, s2, 7
    v_readfirstlane_b32 s4, v2
    s_lshr_b32 s56, s2, 3
    s_mul_i32 s5, s56, 37
    s_lshr_b32 s5, s5, 8
    s_mul_i32 s6, s5, 7
    s_sub_u32 s6, s56, s6
    s_lshr_b32 s49, s3, 1
    s_lshl_b32 s49, s49, 2
    s_add_u32 s49, s49, s5
    s_and_b32 s50, s3, 1
    s_mul_i32 s50, s50, 7
    s_add_u32 s50, s50, s6
    s_and_b32 s51, s56, 1
    s_lshl_b32 s7, s3, 1
    s_add_u32 s51, s51, s7
    s_lshr_b32 s52, s56, 1
    s_lshl_b32 s53, s3, 2
    s_add_u32 s53, s53, s5
    s_mov_b32 s54, s6
    s_and_b32 s48, s4, 3
    s_lshl_b32 s57, s49, 1
    s_add_u32 s57, s57, s50
    s_mul_i32 s7, s57, 37
    s_lshr_b32 s7, s7, 8
    s_mul_i32 s7, s7, 7
    s_sub_u32 s57, s57, s7
    s_add_u32 s58, s57, 1
    s_cmp_eq_u32 s58, 7
    s_cselect_b32 s58, 0, s58
    s_add_u32 s59, s58, 1
    s_cmp_eq_u32 s59, 7
    s_cselect_b32 s59, 0, s59
    s_add_u32 s60, s59, 1
    s_cmp_eq_u32 s60, 7
    s_cselect_b32 s60, 0, s60
    s_add_u32 s61, s60, 1
    s_cmp_eq_u32 s61, 7
    s_cselect_b32 s61, 0, s61
    s_add_u32 s62, s61, 1
    s_cmp_eq_u32 s62, 7
    s_cselect_b32 s62, 0, s62
    s_add_u32 s63, s62, 1
    s_cmp_eq_u32 s63, 7
    s_cselect_b32 s63, 0, s63
    v_mov_b32 v27, 143360
    v_mov_b32 v30, 1
    s_waitcnt lgkmcnt(0)
    s_mov_b32 s8, s64
    s_and_b32 s9, s65, 0xffff
    s_mov_b32 s10, 1835008
    s_mov_b32 s11, 0x00020000
    s_mov_b32 s24, s84
    s_and_b32 s25, s85, 0xffff
    s_mov_b32 s26, 17039360
    s_mov_b32 s27, 0x00020000
    s_add_u32 s86, s84, 16777216
    s_addc_u32 s87, s85, 0
    s_load_dword s44, s[86:87], 0
    s_cmp_lt_u32 s4, 4
    s_cbranch_scc1 A_start
    v_mov_b32 v2, 0
    v_lshl_add_u32 v3, v1, 2, v27
    ds_write_b32 v3, v2
    s_waitcnt lgkmcnt(0)
    s_mul_i32 s55, s44, 0x9E3779B1
    s_add_u32 s55, s55, 0x7F4A7C15
    s_branch B_start
A_start:
    s_setprio 2
    v_lshrrev_b32 v24, 5, v1
    v_lshlrev_b32 v21, 3, v1
    v_lshlrev_b32 v22, 4, v1
    v_mov_b32 v5, 0
    s_cmp_ge_u32 s56, 28
    s_cbranch_scc1 A_helper
    s_lshl_b32 s86, s49, 2
    s_add_u32 s86, s86, s48
    v_lshrrev_b32 v2, 3, v1
    v_and_b32 v3, 7, v1
    v_lshrrev_b32 v4, 1, v2
    v_xor_b32 v5, v3, v4
    v_mul_u32_u24 v6, 896, v2
    v_lshl_add_u32 v8, v5, 4, v6
    v_xor_b32 v5, 4, v5
    v_lshl_add_u32 v9, v5, 4, v6
    v_add_u32 v9, 6144, v9
    v_add_u32 v10, 12288, v8
    v_add_u32 v11, 12288, v9
    s_mul_i32 s87, s86, 28672
    s_mul_i32 s88, s48, 14336
    s_lshl_b32 s89, s57, 7
    s_add_u32 s89, s89, s87
    s_add_u32 m0, s88, 0
    s_nop 0
    buffer_load_dwordx4 v8, s[8:11], s89 offen offset:0 lds
    buffer_load_dwordx4 v9, s[8:11], s89 offen offset:1024 lds
    buffer_load_dwordx4 v10, s[8:11], s89 offen offset:2048 lds
    buffer_load_dwordx4 v11, s[8:11], s89 offen offset:3072 lds
    s_lshl_b32 s89, s58, 7
    s_add_u32 s89, s89, s87
    s_add_u32 m0, s88, 4096
    s_nop 0
    buffer_load_dwordx4 v8, s[8:11], s89 offen offset:0 lds
    buffer_load_dwordx4 v9, s[8:11], s89 offen offset:1024 lds
    buffer_load_dwordx4 v10, s[8:11], s89 offen offset:2048 lds
    buffer_load_dwordx4 v11, s[8:11], s89 offen offset:3072 lds
    s_lshl_b32 s89, s59, 7
    s_add_u32 s89, s89, s87
    s_add_u32 m0, s88, 8192
    s_nop 0
    buffer_load_dwordx4 v8, s[8:11], s89 offen offset:0 lds
    buffer_load_dwordx4 v9, s[8:11], s89 offen offset:1024 lds
    buffer_load_dwordx4 v10, s[8:11], s89 offen offset:2048 lds
    buffer_load_dwordx4 v11, s[8:11], s89 offen offset:3072 lds
    v_and_b32 v2, 31, v1
    v_bfe_u32 v3, v2, 1, 3
    v_lshlrev_b32 v4, 7, v2
    v_add_u32 v4, s88, v4
    v_add_u32 v5, 0, v24
    v_xor_b32 v5, v5, v3
    v_lshl_add_u32 v12, v5, 4, v4
    v_add_u32 v5, 2, v24
    v_xor_b32 v5, v5, v3
    v_lshl_add_u32 v13, v5, 4, v4
    v_add_u32 v5, 4, v24
    v_xor_b32 v5, v5, v3
    v_lshl_add_u32 v14, v5, 4, v4
    v_add_u32 v5, 6, v24
    v_xor_b32 v5, v5, v3
    v_lshl_add_u32 v15, v5, 4, v4
    v_and_b32 v2, 15, v1
    v_bfe_u32 v3, v1, 4, 1
    v_lshrrev_b32 v4, 2, v2
    v_bfe_u32 v5, v2, 1, 1
    v_lshl_add_u32 v5, v3, 1, v5
    v_bfe_u32 v6, v2, 3, 1
    v_lshlrev_b32 v6, 2, v6
    v_xor_b32 v5, v5, v6
    v_lshlrev_b32 v7, 10, v24
    v_lshl_add_u32 v7, v4, 7, v7
    v_and_b32 v6, 1, v2
    v_lshl_add_u32 v7, v6, 3, v7
    v_lshl_add_u32 v16, v5, 4, v7
    v_xor_b32 v5, 4, v5
    v_lshl_add_u32 v17, v5, 4, v7
    v_lshl_add_u32 v7, v24, 3, v4
    v_lshlrev_b32 v7, 6, v7
    v_lshl_add_u32 v7, v3, 5, v7
    v_and_b32 v6, 3, v2
    v_lshl_add_u32 v20, v6, 3, v7
    v_add_u32 v20, 114688, v20
    v_add_u32 v18, 57344, v16
    v_add_u32 v19, 57344, v17
    v_and_b32 v2, 31, v1
    v_mul_u32_u24 v23, 7168, v24
    v_lshl_add_u32 v23, v2, 4, v23
    v_lshlrev_b32 v28, 4, v24
    v_add_u32 v28, 144384, v28
    s_mul_i32 s64, s50, 192
    s_and_b32 s65, s50, 1
    s_lshl_b32 s66, s65, 6
    s_add_u32 s66, s64, s66
    s_xor_b32 s65, s65, 1
    s_lshl_b32 s65, s65, 7
    s_add_u32 s64, s64, s65
    s_mul_i32 s65, s86, 57344
    s_lshl_b32 s67, s64, 5
    s_add_u32 s67, s67, s65
    s_lshl_b32 s68, s66, 5
    s_add_u32 s68, s68, s65
    s_mul_i32 s65, s86, 28672
    s_add_u32 s65, s65, 4179968
    s_lshl_b32 s69, s64, 3
    s_add_u32 s69, s69, s65
    s_add_u32 s70, s69, 14336
    s_lshl_b32 s71, s66, 3
    s_add_u32 s71, s71, s65
    s_add_u32 s72, s71, 14336
    s_mul_i32 s73, s86, 114688
    s_lshl_b32 s65, s50, 13
    s_add_u32 s73, s73, s65
    s_add_u32 s73, s73, 6291456
    s_add_u32 s74, s73, 4096
    s_lshl_b32 s75, s49, 4
    s_add_u32 s75, s75, s50
    s_lshl_b32 s75, s75, 7
    s_add_u32 s75, s75, 16809984
    s_add_u32 s76, s75, 0x8000
    s_add_u32 s77, s75, 0x10000
    s_mov_b32 s78, 0x3f803f80
    v_mov_b32 v32, 0
    v_mov_b32 v33, 0
    v_mov_b32 v34, 0
    v_mov_b32 v35, 0
    s_waitcnt lgkmcnt(0)
    s_mul_i32 s55, s44, 0x9E3779B1
    s_add_u32 s55, s55, 0x7F4A7C15
    s_barrier
    s_waitcnt vmcnt(8)
    ds_read_b128 v[128:131], v12 offset:0
    ds_read_b128 v[132:135], v13 offset:0
    ds_read_b128 v[136:139], v14 offset:0
    ds_read_b128 v[140:143], v15 offset:0
    s_waitcnt lgkmcnt(0)
    s_lshl_b32 s89, s60, 7
    s_add_u32 s89, s89, s87
    s_add_u32 m0, s88, 0
    s_nop 0
    buffer_load_dwordx4 v8, s[8:11], s89 offen offset:0 lds
    buffer_load_dwordx4 v9, s[8:11], s89 offen offset:1024 lds
    buffer_load_dwordx4 v10, s[8:11], s89 offen offset:2048 lds
    buffer_load_dwordx4 v11, s[8:11], s89 offen offset:3072 lds
    s_waitcnt vmcnt(8)
    ds_read_b128 v[144:147], v12 offset:4096
    ds_read_b128 v[148:151], v13 offset:4096
    ds_read_b128 v[152:155], v14 offset:4096
    ds_read_b128 v[156:159], v15 offset:4096
    v_dot2c_f32_bf16 v32, s78, v128
    v_dot2c_f32_bf16 v34, v128, v128
    v_dot2c_f32_bf16 v33, s78, v129
    v_dot2c_f32_bf16 v35, v129, v129
    v_dot2c_f32_bf16 v32, s78, v130
    v_dot2c_f32_bf16 v34, v130, v130
    v_dot2c_f32_bf16 v33, s78, v131
    v_dot2c_f32_bf16 v35, v131, v131
    v_dot2c_f32_bf16 v32, s78, v132
    v_dot2c_f32_bf16 v34, v132, v132
    v_dot2c_f32_bf16 v33, s78, v133
    v_dot2c_f32_bf16 v35, v133, v133
    v_dot2c_f32_bf16 v32, s78, v134
    v_dot2c_f32_bf16 v34, v134, v134
    v_dot2c_f32_bf16 v33, s78, v135
    v_dot2c_f32_bf16 v35, v135, v135
    v_dot2c_f32_bf16 v32, s78, v136
    v_dot2c_f32_bf16 v34, v136, v136
    v_dot2c_f32_bf16 v33, s78, v137
    v_dot2c_f32_bf16 v35, v137, v137
    v_dot2c_f32_bf16 v32, s78, v138
    v_dot2c_f32_bf16 v34, v138, v138
    v_dot2c_f32_bf16 v33, s78, v139
    v_dot2c_f32_bf16 v35, v139, v139
    v_dot2c_f32_bf16 v32, s78, v140
    v_dot2c_f32_bf16 v34, v140, v140
    v_dot2c_f32_bf16 v33, s78, v141
    v_dot2c_f32_bf16 v35, v141, v141
    v_dot2c_f32_bf16 v32, s78, v142
    v_dot2c_f32_bf16 v34, v142, v142
    v_dot2c_f32_bf16 v33, s78, v143
    v_dot2c_f32_bf16 v35, v143, v143
    s_waitcnt lgkmcnt(0)
    s_lshl_b32 s89, s61, 7
    s_add_u32 s89, s89, s87
    s_add_u32 m0, s88, 4096
    s_nop 0
    buffer_load_dwordx4 v8, s[8:11], s89 offen offset:0 lds
    buffer_load_dwordx4 v9, s[8:11], s89 offen offset:1024 lds
    buffer_load_dwordx4 v10, s[8:11], s89 offen offset:2048 lds
    buffer_load_dwordx4 v11, s[8:11], s89 offen offset:3072 lds
    s_waitcnt vmcnt(8)
    ds_read_b128 v[160:163], v12 offset:8192
    ds_read_b128 v[164:167], v13 offset:8192
    ds_read_b128 v[168:171], v14 offset:8192
    ds_read_b128 v[172:175], v15 offset:8192
    v_dot2c_f32_bf16 v32, s78, v144
    v_dot2c_f32_bf16 v34, v144, v144
    v_dot2c_f32_bf16 v33, s78, v145
    v_dot2c_f32_bf16 v35, v145, v145
    v_dot2c_f32_bf16 v32, s78, v146
    v_dot2c_f32_bf16 v34, v146, v146
    v_dot2c_f32_bf16 v33, s78, v147
    v_dot2c_f32_bf16 v35, v147, v147
    v_dot2c_f32_bf16 v32, s78, v148
    v_dot2c_f32_bf16 v34, v148, v148
    v_dot2c_f32_bf16 v33, s78, v149
    v_dot2c_f32_bf16 v35, v149, v149
    v_dot2c_f32_bf16 v32, s78, v150
    v_dot2c_f32_bf16 v34, v150, v150
    v_dot2c_f32_bf16 v33, s78, v151
    v_dot2c_f32_bf16 v35, v151, v151
    v_dot2c_f32_bf16 v32, s78, v152
    v_dot2c_f32_bf16 v34, v152, v152
    v_dot2c_f32_bf16 v33, s78, v153
    v_dot2c_f32_bf16 v35, v153, v153
    v_dot2c_f32_bf16 v32, s78, v154
    v_dot2c_f32_bf16 v34, v154, v154
    v_dot2c_f32_bf16 v33, s78, v155
    v_dot2c_f32_bf16 v35, v155, v155
    v_dot2c_f32_bf16 v32, s78, v156
    v_dot2c_f32_bf16 v34, v156, v156
    v_dot2c_f32_bf16 v33, s78, v157
    v_dot2c_f32_bf16 v35, v157, v157
    v_dot2c_f32_bf16 v32, s78, v158
    v_dot2c_f32_bf16 v34, v158, v158
    v_dot2c_f32_bf16 v33, s78, v159
    v_dot2c_f32_bf16 v35, v159, v159
    s_waitcnt lgkmcnt(0)
    s_lshl_b32 s89, s62, 7
    s_add_u32 s89, s89, s87
    s_add_u32 m0, s88, 8192
    s_nop 0
    buffer_load_dwordx4 v8, s[8:11], s89 offen offset:0 lds
    buffer_load_dwordx4 v9, s[8:11], s89 offen offset:1024 lds
    buffer_load_dwordx4 v10, s[8:11], s89 offen offset:2048 lds
    buffer_load_dwordx4 v11, s[8:11], s89 offen offset:3072 lds
    s_mov_b64 exec, 1
    ds_add_u32 v27, v30 offset:0
    s_mov_b64 exec, -1
    s_waitcnt vmcnt(8)
    ds_read_b128 v[176:179], v12 offset:0
    ds_read_b128 v[180:183], v13 offset:0
    ds_read_b128 v[184:187], v14 offset:0
    ds_read_b128 v[188:191], v15 offset:0
    v_dot2c_f32_bf16 v32, s78, v160
    v_dot2c_f32_bf16 v34, v160, v160
    v_dot2c_f32_bf16 v33, s78, v161
    v_dot2c_f32_bf16 v35, v161, v161
    v_dot2c_f32_bf16 v32, s78, v162
    v_dot2c_f32_bf16 v34, v162, v162
    v_dot2c_f32_bf16 v33, s78, v163
    v_dot2c_f32_bf16 v35, v163, v163
    v_dot2c_f32_bf16 v32, s78, v164
    v_dot2c_f32_bf16 v34, v164, v164
    v_dot2c_f32_bf16 v33, s78, v165
    v_dot2c_f32_bf16 v35, v165, v165
    v_dot2c_f32_bf16 v32, s78, v166
    v_dot2c_f32_bf16 v34, v166, v166
    v_dot2c_f32_bf16 v33, s78, v167
    v_dot2c_f32_bf16 v35, v167, v167
    v_dot2c_f32_bf16 v32, s78, v168
    v_dot2c_f32_bf16 v34, v168, v168
    v_dot2c_f32_bf16 v33, s78, v169
    v_dot2c_f32_bf16 v35, v169, v169
    v_dot2c_f32_bf16 v32, s78, v170
    v_dot2c_f32_bf16 v34, v170, v170
    v_dot2c_f32_bf16 v33, s78, v171
    v_dot2c_f32_bf16 v35, v171, v171
    v_dot2c_f32_bf16 v32, s78, v172
    v_dot2c_f32_bf16 v34, v172, v172
    v_dot2c_f32_bf16 v33, s78, v173
    v_dot2c_f32_bf16 v35, v173, v173
    v_dot2c_f32_bf16 v32, s78, v174
    v_dot2c_f32_bf16 v34, v174, v174
    v_dot2c_f32_bf16 v33, s78, v175
    v_dot2c_f32_bf16 v35, v175, v175
    s_waitcnt lgkmcnt(0)
    s_lshl_b32 s89, s63, 7
    s_add_u32 s89, s89, s87
    s_add_u32 m0, s88, 0
    s_nop 0
    buffer_load_dwordx4 v8, s[8:11], s89 offen offset:0 lds
    buffer_load_dwordx4 v9, s[8:11], s89 offen offset:1024 lds
    buffer_load_dwordx4 v10, s[8:11], s89 offen offset:2048 lds
    buffer_load_dwordx4 v11, s[8:11], s89 offen offset:3072 lds
    s_waitcnt vmcnt(8)
    ds_read_b128 v[192:195], v12 offset:4096
    ds_read_b128 v[196:199], v13 offset:4096
    ds_read_b128 v[200:203], v14 offset:4096
    ds_read_b128 v[204:207], v15 offset:4096
    v_dot2c_f32_bf16 v32, s78, v176
    v_dot2c_f32_bf16 v34, v176, v176
    v_dot2c_f32_bf16 v33, s78, v177
    v_dot2c_f32_bf16 v35, v177, v177
    v_dot2c_f32_bf16 v32, s78, v178
    v_dot2c_f32_bf16 v34, v178, v178
    v_dot2c_f32_bf16 v33, s78, v179
    v_dot2c_f32_bf16 v35, v179, v179
    v_dot2c_f32_bf16 v32, s78, v180
    v_dot2c_f32_bf16 v34, v180, v180
    v_dot2c_f32_bf16 v33, s78, v181
    v_dot2c_f32_bf16 v35, v181, v181
    v_dot2c_f32_bf16 v32, s78, v182
    v_dot2c_f32_bf16 v34, v182, v182
    v_dot2c_f32_bf16 v33, s78, v183
    v_dot2c_f32_bf16 v35, v183, v183
    v_dot2c_f32_bf16 v32, s78, v184
    v_dot2c_f32_bf16 v34, v184, v184
    v_dot2c_f32_bf16 v33, s78, v185
    v_dot2c_f32_bf16 v35, v185, v185
    v_dot2c_f32_bf16 v32, s78, v186
    v_dot2c_f32_bf16 v34, v186, v186
    v_dot2c_f32_bf16 v33, s78, v187
    v_dot2c_f32_bf16 v35, v187, v187
    v_dot2c_f32_bf16 v32, s78, v188
    v_dot2c_f32_bf16 v34, v188, v188
    v_dot2c_f32_bf16 v33, s78, v189
    v_dot2c_f32_bf16 v35, v189, v189
    v_dot2c_f32_bf16 v32, s78, v190
    v_dot2c_f32_bf16 v34, v190, v190
    v_dot2c_f32_bf16 v33, s78, v191
    v_dot2c_f32_bf16 v35, v191, v191
    s_waitcnt lgkmcnt(0)
    s_waitcnt vmcnt(4)
    ds_read_b128 v[208:211], v12 offset:8192
    ds_read_b128 v[212:215], v13 offset:8192
    ds_read_b128 v[216:219], v14 offset:8192
    ds_read_b128 v[220:223], v15 offset:8192
    v_dot2c_f32_bf16 v32, s78, v192
    v_dot2c_f32_bf16 v34, v192, v192
    v_dot2c_f32_bf16 v33, s78, v193
    v_dot2c_f32_bf16 v35, v193, v193
    v_dot2c_f32_bf16 v32, s78, v194
    v_dot2c_f32_bf16 v34, v194, v194
    v_dot2c_f32_bf16 v33, s78, v195
    v_dot2c_f32_bf16 v35, v195, v195
    v_dot2c_f32_bf16 v32, s78, v196
    v_dot2c_f32_bf16 v34, v196, v196
    v_dot2c_f32_bf16 v33, s78, v197
    v_dot2c_f32_bf16 v35, v197, v197
    v_dot2c_f32_bf16 v32, s78, v198
    v_dot2c_f32_bf16 v34, v198, v198
    v_dot2c_f32_bf16 v33, s78, v199
    v_dot2c_f32_bf16 v35, v199, v199
    v_dot2c_f32_bf16 v32, s78, v200
    v_dot2c_f32_bf16 v34, v200, v200
    v_dot2c_f32_bf16 v33, s78, v201
    v_dot2c_f32_bf16 v35, v201, v201
    v_dot2c_f32_bf16 v32, s78, v202
    v_dot2c_f32_bf16 v34, v202, v202
    v_dot2c_f32_bf16 v33, s78, v203
    v_dot2c_f32_bf16 v35, v203, v203
    v_dot2c_f32_bf16 v32, s78, v204
    v_dot2c_f32_bf16 v34, v204, v204
    v_dot2c_f32_bf16 v33, s78, v205
    v_dot2c_f32_bf16 v35, v205, v205
    v_dot2c_f32_bf16 v32, s78, v206
    v_dot2c_f32_bf16 v34, v206, v206
    v_dot2c_f32_bf16 v33, s78, v207
    v_dot2c_f32_bf16 v35, v207, v207
    s_waitcnt lgkmcnt(0)
    s_waitcnt vmcnt(0)
    ds_read_b128 v[224:227], v12 offset:0
    ds_read_b128 v[228:231], v13 offset:0
    ds_read_b128 v[232:235], v14 offset:0
    ds_read_b128 v[236:239], v15 offset:0
    v_dot2c_f32_bf16 v32, s78, v208
    v_dot2c_f32_bf16 v34, v208, v208
    v_dot2c_f32_bf16 v33, s78, v209
    v_dot2c_f32_bf16 v35, v209, v209
    v_dot2c_f32_bf16 v32, s78, v210
    v_dot2c_f32_bf16 v34, v210, v210
    v_dot2c_f32_bf16 v33, s78, v211
    v_dot2c_f32_bf16 v35, v211, v211
    v_dot2c_f32_bf16 v32, s78, v212
    v_dot2c_f32_bf16 v34, v212, v212
    v_dot2c_f32_bf16 v33, s78, v213
    v_dot2c_f32_bf16 v35, v213, v213
    v_dot2c_f32_bf16 v32, s78, v214
    v_dot2c_f32_bf16 v34, v214, v214
    v_dot2c_f32_bf16 v33, s78, v215
    v_dot2c_f32_bf16 v35, v215, v215
    v_dot2c_f32_bf16 v32, s78, v216
    v_dot2c_f32_bf16 v34, v216, v216
    v_dot2c_f32_bf16 v33, s78, v217
    v_dot2c_f32_bf16 v35, v217, v217
    v_dot2c_f32_bf16 v32, s78, v218
    v_dot2c_f32_bf16 v34, v218, v218
    v_dot2c_f32_bf16 v33, s78, v219
    v_dot2c_f32_bf16 v35, v219, v219
    v_dot2c_f32_bf16 v32, s78, v220
    v_dot2c_f32_bf16 v34, v220, v220
    v_dot2c_f32_bf16 v33, s78, v221
    v_dot2c_f32_bf16 v35, v221, v221
    v_dot2c_f32_bf16 v32, s78, v222
    v_dot2c_f32_bf16 v34, v222, v222
    v_dot2c_f32_bf16 v33, s78, v223
    v_dot2c_f32_bf16 v35, v223, v223
    s_waitcnt lgkmcnt(0)
    s_mov_b64 exec, 1
    ds_add_u32 v27, v30 offset:4
    s_mov_b64 exec, -1
    v_dot2c_f32_bf16 v32, s78, v224
    v_dot2c_f32_bf16 v34, v224, v224
    v_dot2c_f32_bf16 v33, s78, v225
    v_dot2c_f32_bf16 v35, v225, v225
    v_dot2c_f32_bf16 v32, s78, v226
    v_dot2c_f32_bf16 v34, v226, v226
    v_dot2c_f32_bf16 v33, s78, v227
    v_dot2c_f32_bf16 v35, v227, v227
    v_dot2c_f32_bf16 v32, s78, v228
    v_dot2c_f32_bf16 v34, v228, v228
    v_dot2c_f32_bf16 v33, s78, v229
    v_dot2c_f32_bf16 v35, v229, v229
    v_dot2c_f32_bf16 v32, s78, v230
    v_dot2c_f32_bf16 v34, v230, v230
    v_dot2c_f32_bf16 v33, s78, v231
    v_dot2c_f32_bf16 v35, v231, v231
    v_dot2c_f32_bf16 v32, s78, v232
    v_dot2c_f32_bf16 v34, v232, v232
    v_dot2c_f32_bf16 v33, s78, v233
    v_dot2c_f32_bf16 v35, v233, v233
    v_dot2c_f32_bf16 v32, s78, v234
    v_dot2c_f32_bf16 v34, v234, v234
    v_dot2c_f32_bf16 v33, s78, v235
    v_dot2c_f32_bf16 v35, v235, v235
    v_dot2c_f32_bf16 v32, s78, v236
    v_dot2c_f32_bf16 v34, v236, v236
    v_dot2c_f32_bf16 v33, s78, v237
    v_dot2c_f32_bf16 v35, v237, v237
    v_dot2c_f32_bf16 v32, s78, v238
    v_dot2c_f32_bf16 v34, v238, v238
    v_dot2c_f32_bf16 v33, s78, v239
    v_dot2c_f32_bf16 v35, v239, v239
    s_nop 1
    v_add_f32 v32, v32, v33
    v_add_f32 v34, v34, v35
    v_mov_b32 v33, v32
    v_mov_b32 v35, v34
    s_nop 0
    v_permlane32_swap_b32 v32, v33
    v_permlane32_swap_b32 v34, v35
    v_add_f32 v32, v32, v33
    v_add_f32 v34, v34, v35
    v_mul_f32 v32, 0x3b124925, v32
    v_mul_f32 v34, 0x3b124925, v34
    v_fma_f32 v34, -v32, v32, v34
    v_cvt_pk_bf16_f32 v33, v32, v32
    v_and_b32 v33, 0xffff0000, v33
    v_sub_f32 v7, 0, v33
    v_max_f32 v34, 0, v34
    v_cvt_pk_bf16_f32 v34, v34, v34
    v_and_b32 v34, 0xffff0000, v34
    v_add_f32 v34, 0x3727c5ac, v34
    v_cvt_pk_bf16_f32 v34, v34, v34
    v_and_b32 v34, 0xffff0000, v34
    v_sqrt_f32 v34, v34
    s_nop 0
    v_cvt_pk_bf16_f32 v34, v34, v34
    v_and_b32 v34, 0xffff0000, v34
    v_rcp_f32 v25, v34
    v_and_b32 v2, 31, v1
    s_lshl_b32 s65, s48, 7
    s_add_u32 s65, s65, 143616
    v_lshl_add_u32 v2, v2, 2, s65
    ds_write_b32 v2, v25
    v_lshl_add_u32 v12, v24, 4, s65
    v_mov_b32 v6, s55
    s_mov_b32 s78, 0x00003f80
    s_mov_b32 s79, 0x3f800000
    v_dot2_f32_bf16 v64, v128, s78, v7
    v_dot2_f32_bf16 v65, v128, s79, v7
    v_dot2_f32_bf16 v66, v129, s78, v7
    v_dot2_f32_bf16 v67, v129, s79, v7
    v_dot2_f32_bf16 v68, v130, s78, v7
    v_dot2_f32_bf16 v69, v130, s79, v7
    v_dot2_f32_bf16 v70, v131, s78, v7
    v_dot2_f32_bf16 v71, v131, s79, v7
    v_dot2_f32_bf16 v72, v132, s78, v7
    v_dot2_f32_bf16 v73, v132, s79, v7
    v_dot2_f32_bf16 v74, v133, s78, v7
    v_dot2_f32_bf16 v75, v133, s79, v7
    v_dot2_f32_bf16 v76, v134, s78, v7
    v_dot2_f32_bf16 v77, v134, s79, v7
    v_dot2_f32_bf16 v78, v135, s78, v7
    v_dot2_f32_bf16 v79, v135, s79, v7
    v_cvt_pk_bf16_f32 v128, v64, v65
    v_cvt_pk_bf16_f32 v129, v66, v67
    v_cvt_pk_bf16_f32 v130, v68, v69
    v_cvt_pk_bf16_f32 v131, v70, v71
    v_dot2_f32_bf16 v64, v136, s78, v7
    v_dot2_f32_bf16 v65, v136, s79, v7
    v_dot2_f32_bf16 v66, v137, s78, v7
    v_dot2_f32_bf16 v67, v137, s79, v7
    v_dot2_f32_bf16 v68, v138, s78, v7
    v_dot2_f32_bf16 v69, v138, s79, v7
    v_dot2_f32_bf16 v70, v139, s78, v7
    v_dot2_f32_bf16 v71, v139, s79, v7
    v_cvt_pk_bf16_f32 v132, v72, v73
    v_cvt_pk_bf16_f32 v133, v74, v75
    v_cvt_pk_bf16_f32 v134, v76, v77
    v_cvt_pk_bf16_f32 v135, v78, v79
    v_dot2_f32_bf16 v72, v140, s78, v7
    v_dot2_f32_bf16 v73, v140, s79, v7
    v_dot2_f32_bf16 v74, v141, s78, v7
    v_dot2_f32_bf16 v75, v141, s79, v7
    v_dot2_f32_bf16 v76, v142, s78, v7
    v_dot2_f32_bf16 v77, v142, s79, v7
    v_dot2_f32_bf16 v78, v143, s78, v7
    v_dot2_f32_bf16 v79, v143, s79, v7
    v_cvt_pk_bf16_f32 v136, v64, v65
    v_cvt_pk_bf16_f32 v137, v66, v67
    v_cvt_pk_bf16_f32 v138, v68, v69
    v_cvt_pk_bf16_f32 v139, v70, v71
    v_dot2_f32_bf16 v64, v144, s78, v7
    v_dot2_f32_bf16 v65, v144, s79, v7
    v_dot2_f32_bf16 v66, v145, s78, v7
    v_dot2_f32_bf16 v67, v145, s79, v7
    v_dot2_f32_bf16 v68, v146, s78, v7
    v_dot2_f32_bf16 v69, v146, s79, v7
    v_dot2_f32_bf16 v70, v147, s78, v7
    v_dot2_f32_bf16 v71, v147, s79, v7
    v_cvt_pk_bf16_f32 v140, v72, v73
    v_cvt_pk_bf16_f32 v141, v74, v75
    v_cvt_pk_bf16_f32 v142, v76, v77
    v_cvt_pk_bf16_f32 v143, v78, v79
    v_dot2_f32_bf16 v72, v148, s78, v7
    v_dot2_f32_bf16 v73, v148, s79, v7
    v_dot2_f32_bf16 v74, v149, s78, v7
    v_dot2_f32_bf16 v75, v149, s79, v7
    v_dot2_f32_bf16 v76, v150, s78, v7
    v_dot2_f32_bf16 v77, v150, s79, v7
    v_dot2_f32_bf16 v78, v151, s78, v7
    v_dot2_f32_bf16 v79, v151, s79, v7
    v_cvt_pk_bf16_f32 v144, v64, v65
    v_cvt_pk_bf16_f32 v145, v66, v67
    v_cvt_pk_bf16_f32 v146, v68, v69
    v_cvt_pk_bf16_f32 v147, v70, v71
    v_dot2_f32_bf16 v64, v152, s78, v7
    v_dot2_f32_bf16 v65, v152, s79, v7
    v_dot2_f32_bf16 v66, v153, s78, v7
    v_dot2_f32_bf16 v67, v153, s79, v7
    v_dot2_f32_bf16 v68, v154, s78, v7
    v_dot2_f32_bf16 v69, v154, s79, v7
    v_dot2_f32_bf16 v70, v155, s78, v7
    v_dot2_f32_bf16 v71, v155, s79, v7
    v_cvt_pk_bf16_f32 v148, v72, v73
    v_cvt_pk_bf16_f32 v149, v74, v75
    v_cvt_pk_bf16_f32 v150, v76, v77
    v_cvt_pk_bf16_f32 v151, v78, v79
    v_dot2_f32_bf16 v72, v156, s78, v7
    v_dot2_f32_bf16 v73, v156, s79, v7
    v_dot2_f32_bf16 v74, v157, s78, v7
    v_dot2_f32_bf16 v75, v157, s79, v7
    v_dot2_f32_bf16 v76, v158, s78, v7
    v_dot2_f32_bf16 v77, v158, s79, v7
    v_dot2_f32_bf16 v78, v159, s78, v7
    v_dot2_f32_bf16 v79, v159, s79, v7
    v_cvt_pk_bf16_f32 v152, v64, v65
    v_cvt_pk_bf16_f32 v153, v66, v67
    v_cvt_pk_bf16_f32 v154, v68, v69
    v_cvt_pk_bf16_f32 v155, v70, v71
    v_dot2_f32_bf16 v64, v160, s78, v7
    v_dot2_f32_bf16 v65, v160, s79, v7
    v_dot2_f32_bf16 v66, v161, s78, v7
    v_dot2_f32_bf16 v67, v161, s79, v7
    v_dot2_f32_bf16 v68, v162, s78, v7
    v_dot2_f32_bf16 v69, v162, s79, v7
    v_dot2_f32_bf16 v70, v163, s78, v7
    v_dot2_f32_bf16 v71, v163, s79, v7
    v_cvt_pk_bf16_f32 v156, v72, v73
    v_cvt_pk_bf16_f32 v157, v74, v75
    v_cvt_pk_bf16_f32 v158, v76, v77
    v_cvt_pk_bf16_f32 v159, v78, v79
    v_dot2_f32_bf16 v72, v164, s78, v7
    v_dot2_f32_bf16 v73, v164, s79, v7
    v_dot2_f32_bf16 v74, v165, s78, v7
    v_dot2_f32_bf16 v75, v165, s79, v7
    v_dot2_f32_bf16 v76, v166, s78, v7
    v_dot2_f32_bf16 v77, v166, s79, v7
    v_dot2_f32_bf16 v78, v167, s78, v7
    v_dot2_f32_bf16 v79, v167, s79, v7
    v_cvt_pk_bf16_f32 v160, v64, v65
    v_cvt_pk_bf16_f32 v161, v66, v67
    v_cvt_pk_bf16_f32 v162, v68, v69
    v_cvt_pk_bf16_f32 v163, v70, v71
    v_dot2_f32_bf16 v64, v168, s78, v7
    v_dot2_f32_bf16 v65, v168, s79, v7
    v_dot2_f32_bf16 v66, v169, s78, v7
    v_dot2_f32_bf16 v67, v169, s79, v7
    v_dot2_f32_bf16 v68, v170, s78, v7
    v_dot2_f32_bf16 v69, v170, s79, v7
    v_dot2_f32_bf16 v70, v171, s78, v7
    v_dot2_f32_bf16 v71, v171, s79, v7
    v_cvt_pk_bf16_f32 v164, v72, v73
    v_cvt_pk_bf16_f32 v165, v74, v75
    v_cvt_pk_bf16_f32 v166, v76, v77
    v_cvt_pk_bf16_f32 v167, v78, v79
    v_dot2_f32_bf16 v72, v172, s78, v7
    v_dot2_f32_bf16 v73, v172, s79, v7
    v_dot2_f32_bf16 v74, v173, s78, v7
    v_dot2_f32_bf16 v75, v173, s79, v7
    v_dot2_f32_bf16 v76, v174, s78, v7
    v_dot2_f32_bf16 v77, v174, s79, v7
    v_dot2_f32_bf16 v78, v175, s78, v7
    v_dot2_f32_bf16 v79, v175, s79, v7
    v_cvt_pk_bf16_f32 v168, v64, v65
    v_cvt_pk_bf16_f32 v169, v66, v67
    v_cvt_pk_bf16_f32 v170, v68, v69
    v_cvt_pk_bf16_f32 v171, v70, v71
    v_dot2_f32_bf16 v64, v176, s78, v7
    v_dot2_f32_bf16 v65, v176, s79, v7
    v_dot2_f32_bf16 v66, v177, s78, v7
    v_dot2_f32_bf16 v67, v177, s79, v7
    v_dot2_f32_bf16 v68, v178, s78, v7
    v_dot2_f32_bf16 v69, v178, s79, v7
    v_dot2_f32_bf16 v70, v179, s78, v7
    v_dot2_f32_bf16 v71, v179, s79, v7
    v_cvt_pk_bf16_f32 v172, v72, v73
    v_cvt_pk_bf16_f32 v173, v74, v75
    v_cvt_pk_bf16_f32 v174, v76, v77
    v_cvt_pk_bf16_f32 v175, v78, v79
    v_dot2_f32_bf16 v72, v180, s78, v7
    v_dot2_f32_bf16 v73, v180, s79, v7
    v_dot2_f32_bf16 v74, v181, s78, v7
    v_dot2_f32_bf16 v75, v181, s79, v7
    v_dot2_f32_bf16 v76, v182, s78, v7
    v_dot2_f32_bf16 v77, v182, s79, v7
    v_dot2_f32_bf16 v78, v183, s78, v7
    v_dot2_f32_bf16 v79, v183, s79, v7
    v_cvt_pk_bf16_f32 v176, v64, v65
    v_cvt_pk_bf16_f32 v177, v66, v67
    v_cvt_pk_bf16_f32 v178, v68, v69
    v_cvt_pk_bf16_f32 v179, v70, v71
    v_dot2_f32_bf16 v64, v184, s78, v7
    v_dot2_f32_bf16 v65, v184, s79, v7
    v_dot2_f32_bf16 v66, v185, s78, v7
    v_dot2_f32_bf16 v67, v185, s79, v7
    v_dot2_f32_bf16 v68, v186, s78, v7
    v_dot2_f32_bf16 v69, v186, s79, v7
    v_dot2_f32_bf16 v70, v187, s78, v7
    v_dot2_f32_bf16 v71, v187, s79, v7
    v_cvt_pk_bf16_f32 v180, v72, v73
    v_cvt_pk_bf16_f32 v181, v74, v75
    v_cvt_pk_bf16_f32 v182, v76, v77
    v_cvt_pk_bf16_f32 v183, v78, v79
    v_dot2_f32_bf16 v72, v188, s78, v7
    v_dot2_f32_bf16 v73, v188, s79, v7
    v_dot2_f32_bf16 v74, v189, s78, v7
    v_dot2_f32_bf16 v75, v189, s79, v7
    v_dot2_f32_bf16 v76, v190, s78, v7
    v_dot2_f32_bf16 v77, v190, s79, v7
    v_dot2_f32_bf16 v78, v191, s78, v7
    v_dot2_f32_bf16 v79, v191, s79, v7
    v_cvt_pk_bf16_f32 v184, v64, v65
    v_cvt_pk_bf16_f32 v185, v66, v67
    v_cvt_pk_bf16_f32 v186, v68, v69
    v_cvt_pk_bf16_f32 v187, v70, v71
    v_dot2_f32_bf16 v64, v192, s78, v7
    v_dot2_f32_bf16 v65, v192, s79, v7
    v_dot2_f32_bf16 v66, v193, s78, v7
    v_dot2_f32_bf16 v67, v193, s79, v7
    v_dot2_f32_bf16 v68, v194, s78, v7
    v_dot2_f32_bf16 v69, v194, s79, v7
    v_dot2_f32_bf16 v70, v195, s78, v7
    v_dot2_f32_bf16 v71, v195, s79, v7
    v_cvt_pk_bf16_f32 v188, v72, v73
    v_cvt_pk_bf16_f32 v189, v74, v75
    v_cvt_pk_bf16_f32 v190, v76, v77
    v_cvt_pk_bf16_f32 v191, v78, v79
    v_dot2_f32_bf16 v72, v196, s78, v7
    v_dot2_f32_bf16 v73, v196, s79, v7
    v_dot2_f32_bf16 v74, v197, s78, v7
    v_dot2_f32_bf16 v75, v197, s79, v7
    v_dot2_f32_bf16 v76, v198, s78, v7
    v_dot2_f32_bf16 v77, v198, s79, v7
    v_dot2_f32_bf16 v78, v199, s78, v7
    v_dot2_f32_bf16 v79, v199, s79, v7
    v_cvt_pk_bf16_f32 v192, v64, v65
    v_cvt_pk_bf16_f32 v193, v66, v67
    v_cvt_pk_bf16_f32 v194, v68, v69
    v_cvt_pk_bf16_f32 v195, v70, v71
    v_dot2_f32_bf16 v64, v200, s78, v7
    v_dot2_f32_bf16 v65, v200, s79, v7
    v_dot2_f32_bf16 v66, v201, s78, v7
    v_dot2_f32_bf16 v67, v201, s79, v7
    v_dot2_f32_bf16 v68, v202, s78, v7
    v_dot2_f32_bf16 v69, v202, s79, v7
    v_dot2_f32_bf16 v70, v203, s78, v7
    v_dot2_f32_bf16 v71, v203, s79, v7
    v_cvt_pk_bf16_f32 v196, v72, v73
    v_cvt_pk_bf16_f32 v197, v74, v75
    v_cvt_pk_bf16_f32 v198, v76, v77
    v_cvt_pk_bf16_f32 v199, v78, v79
    v_dot2_f32_bf16 v72, v204, s78, v7
    v_dot2_f32_bf16 v73, v204, s79, v7
    v_dot2_f32_bf16 v74, v205, s78, v7
    v_dot2_f32_bf16 v75, v205, s79, v7
    v_dot2_f32_bf16 v76, v206, s78, v7
    v_dot2_f32_bf16 v77, v206, s79, v7
    v_dot2_f32_bf16 v78, v207, s78, v7
    v_dot2_f32_bf16 v79, v207, s79, v7
    v_cvt_pk_bf16_f32 v200, v64, v65
    v_cvt_pk_bf16_f32 v201, v66, v67
    v_cvt_pk_bf16_f32 v202, v68, v69
    v_cvt_pk_bf16_f32 v203, v70, v71
    v_dot2_f32_bf16 v64, v208, s78, v7
    v_dot2_f32_bf16 v65, v208, s79, v7
    v_dot2_f32_bf16 v66, v209, s78, v7
    v_dot2_f32_bf16 v67, v209, s79, v7
    v_dot2_f32_bf16 v68, v210, s78, v7
    v_dot2_f32_bf16 v69, v210, s79, v7
    v_dot2_f32_bf16 v70, v211, s78, v7
    v_dot2_f32_bf16 v71, v211, s79, v7
    v_cvt_pk_bf16_f32 v204, v72, v73
    v_cvt_pk_bf16_f32 v205, v74, v75
    v_cvt_pk_bf16_f32 v206, v76, v77
    v_cvt_pk_bf16_f32 v207, v78, v79
    v_dot2_f32_bf16 v72, v212, s78, v7
    v_dot2_f32_bf16 v73, v212, s79, v7
    v_dot2_f32_bf16 v74, v213, s78, v7
    v_dot2_f32_bf16 v75, v213, s79, v7
    v_dot2_f32_bf16 v76, v214, s78, v7
    v_dot2_f32_bf16 v77, v214, s79, v7
    v_dot2_f32_bf16 v78, v215, s78, v7
    v_dot2_f32_bf16 v79, v215, s79, v7
    v_cvt_pk_bf16_f32 v208, v64, v65
    v_cvt_pk_bf16_f32 v209, v66, v67
    v_cvt_pk_bf16_f32 v210, v68, v69
    v_cvt_pk_bf16_f32 v211, v70, v71
    v_dot2_f32_bf16 v64, v216, s78, v7
    v_dot2_f32_bf16 v65, v216, s79, v7
    v_dot2_f32_bf16 v66, v217, s78, v7
    v_dot2_f32_bf16 v67, v217, s79, v7
    v_dot2_f32_bf16 v68, v218, s78, v7
    v_dot2_f32_bf16 v69, v218, s79, v7
    v_dot2_f32_bf16 v70, v219, s78, v7
    v_dot2_f32_bf16 v71, v219, s79, v7
    v_cvt_pk_bf16_f32 v212, v72, v73
    v_cvt_pk_bf16_f32 v213, v74, v75
    v_cvt_pk_bf16_f32 v214, v76, v77
    v_cvt_pk_bf16_f32 v215, v78, v79
    v_dot2_f32_bf16 v72, v220, s78, v7
    v_dot2_f32_bf16 v73, v220, s79, v7
    v_dot2_f32_bf16 v74, v221, s78, v7
    v_dot2_f32_bf16 v75, v221, s79, v7
    v_dot2_f32_bf16 v76, v222, s78, v7
    v_dot2_f32_bf16 v77, v222, s79, v7
    v_dot2_f32_bf16 v78, v223, s78, v7
    v_dot2_f32_bf16 v79, v223, s79, v7
    v_cvt_pk_bf16_f32 v216, v64, v65
    v_cvt_pk_bf16_f32 v217, v66, v67
    v_cvt_pk_bf16_f32 v218, v68, v69
    v_cvt_pk_bf16_f32 v219, v70, v71
    v_dot2_f32_bf16 v64, v224, s78, v7
    v_dot2_f32_bf16 v65, v224, s79, v7
    v_dot2_f32_bf16 v66, v225, s78, v7
    v_dot2_f32_bf16 v67, v225, s79, v7
    v_dot2_f32_bf16 v68, v226, s78, v7
    v_dot2_f32_bf16 v69, v226, s79, v7
    v_dot2_f32_bf16 v70, v227, s78, v7
    v_dot2_f32_bf16 v71, v227, s79, v7
    v_cvt_pk_bf16_f32 v220, v72, v73
    v_cvt_pk_bf16_f32 v221, v74, v75
    v_cvt_pk_bf16_f32 v222, v76, v77
    v_cvt_pk_bf16_f32 v223, v78, v79
    v_dot2_f32_bf16 v72, v228, s78, v7
    v_dot2_f32_bf16 v73, v228, s79, v7
    v_dot2_f32_bf16 v74, v229, s78, v7
    v_dot2_f32_bf16 v75, v229, s79, v7
    v_dot2_f32_bf16 v76, v230, s78, v7
    v_dot2_f32_bf16 v77, v230, s79, v7
    v_dot2_f32_bf16 v78, v231, s78, v7
    v_dot2_f32_bf16 v79, v231, s79, v7
    v_cvt_pk_bf16_f32 v224, v64, v65
    v_cvt_pk_bf16_f32 v225, v66, v67
    v_cvt_pk_bf16_f32 v226, v68, v69
    v_cvt_pk_bf16_f32 v227, v70, v71
    v_dot2_f32_bf16 v64, v232, s78, v7
    v_dot2_f32_bf16 v65, v232, s79, v7
    v_dot2_f32_bf16 v66, v233, s78, v7
    v_dot2_f32_bf16 v67, v233, s79, v7
    v_dot2_f32_bf16 v68, v234, s78, v7
    v_dot2_f32_bf16 v69, v234, s79, v7
    v_dot2_f32_bf16 v70, v235, s78, v7
    v_dot2_f32_bf16 v71, v235, s79, v7
    v_cvt_pk_bf16_f32 v228, v72, v73
    v_cvt_pk_bf16_f32 v229, v74, v75
    v_cvt_pk_bf16_f32 v230, v76, v77
    v_cvt_pk_bf16_f32 v231, v78, v79
    v_dot2_f32_bf16 v72, v236, s78, v7
    v_dot2_f32_bf16 v73, v236, s79, v7
    v_dot2_f32_bf16 v74, v237, s78, v7
    v_dot2_f32_bf16 v75, v237, s79, v7
    v_dot2_f32_bf16 v76, v238, s78, v7
    v_dot2_f32_bf16 v77, v238, s79, v7
    v_dot2_f32_bf16 v78, v239, s78, v7
    v_dot2_f32_bf16 v79, v239, s79, v7
    v_cvt_pk_bf16_f32 v232, v64, v65
    v_cvt_pk_bf16_f32 v233, v66, v67
    v_cvt_pk_bf16_f32 v234, v68, v69
    v_cvt_pk_bf16_f32 v235, v70, v71
    v_mul_f32 v4, 0x3e8b97f6, v25
    s_cmp_lt_u32 s64, 896
    s_cselect_b64 vcc, -1, 0
    v_cndmask_b32 v2, v25, v4, vcc
    s_cmp_lt_u32 s66, 896
    s_cselect_b64 vcc, -1, 0
    v_cndmask_b32 v3, v25, v4, vcc
    v_cvt_pk_bf16_f32 v236, v72, v73
    v_cvt_pk_bf16_f32 v237, v74, v75
    v_cvt_pk_bf16_f32 v238, v76, v77
    v_cvt_pk_bf16_f32 v239, v78, v79
    s_mov_b32 s78, 0xbdd2d3e8
    v_mov_b32 v26, 0xc0135761
    v_mov_b32 v5, 0
    s_mov_b32 s95, 0
LW_1:
    ds_read_b32 v29, v27 offset:8
    s_add_u32 s95, s95, 1
    s_lshr_b32 s94, s95, 18
    s_waitcnt lgkmcnt(0)
    v_readfirstlane_b32 s97, v29
    s_nop 0
    s_add_u32 s97, s97, s94
    s_cmp_ge_u32 s97, 4
    s_cbranch_scc1 LW_1_d
    s_sleep 2
    s_branch LW_1
LW_1_d:
    s_cmp_ge_u32 s50, 10
    s_cbranch_scc1 A_pc
    s_cmp_eq_u32 s50, 9
    s_cbranch_scc1 A_pb
    ds_read_b64_tr_b16 v[48:49], v18 offset:0
    ds_read_b64_tr_b16 v[50:51], v18 offset:512
    ds_read_b64_tr_b16 v[52:53], v19 offset:0
    ds_read_b64_tr_b16 v[54:55], v19 offset:512
    ds_read_b64_tr_b16 v[56:57], v18 offset:2048
    ds_read_b64_tr_b16 v[58:59], v18 offset:2560
    ds_read_b64_tr_b16 v[60:61], v19 offset:2048
    ds_read_b64_tr_b16 v[62:63], v19 offset:2560
    ds_read_b64_tr_b16 v[240:241], v18 offset:4096
    ds_read_b64_tr_b16 v[242:243], v18 offset:4608
    ds_read_b64_tr_b16 v[244:245], v19 offset:4096
    ds_read_b64_tr_b16 v[246:247], v19 offset:4608
    s_waitcnt lgkmcnt(8)
    ds_read_b64_tr_b16 v[248:249], v18 offset:6144
    ds_read_b64_tr_b16 v[250:251], v18 offset:6656
    ds_read_b64_tr_b16 v[252:253], v19 offset:6144
    ds_read_b64_tr_b16 v[254:255], v19 offset:6656
    v_mfma_f32_32x32x16_bf16 v[64:79], v[48:51], v[128:131], 0
    v_mfma_f32_32x32x16_bf16 v[80:95], v[52:55], v[128:131], 0
    s_waitcnt lgkmcnt(8)
    ds_read_b64_tr_b16 v[48:49], v18 offset:8192
    ds_read_b64_tr_b16 v[50:51], v18 offset:8704
    ds_read_b64_tr_b16 v[52:53], v19 offset:8192
    ds_read_b64_tr_b16 v[54:55], v19 offset:8704
    v_mfma_f32_32x32x16_bf16 v[64:79], v[56:59], v[132:135], v[64:79]
    v_mfma_f32_32x32x16_bf16 v[80:95], v[60:63], v[132:135], v[80:95]
    s_waitcnt lgkmcnt(8)
    ds_read_b64_tr_b16 v[56:57], v18 offset:10240
    ds_read_b64_tr_b16 v[58:59], v18 offset:10752
    ds_read_b64_tr_b16 v[60:61], v19 offset:10240
    ds_read_b64_tr_b16 v[62:63], v19 offset:10752
    v_mfma_f32_32x32x16_bf16 v[64:79], v[240:243], v[136:139], v[64:79]
    v_mfma_f32_32x32x16_bf16 v[80:95], v[244:247], v[136:139], v[80:95]
    s_waitcnt lgkmcnt(8)
    ds_read_b64_tr_b16 v[240:241], v18 offset:12288
    ds_read_b64_tr_b16 v[242:243], v18 offset:12800
    ds_read_b64_tr_b16 v[244:245], v19 offset:12288
    ds_read_b64_tr_b16 v[246:247], v19 offset:12800
    v_mfma_f32_32x32x16_bf16 v[64:79], v[248:251], v[140:143], v[64:79]
    v_mfma_f32_32x32x16_bf16 v[80:95], v[252:255], v[140:143], v[80:95]
    s_waitcnt lgkmcnt(8)
    ds_read_b64_tr_b16 v[248:249], v18 offset:14336
    ds_read_b64_tr_b16 v[250:251], v18 offset:14848
    ds_read_b64_tr_b16 v[252:253], v19 offset:14336
    ds_read_b64_tr_b16 v[254:255], v19 offset:14848
    v_mfma_f32_32x32x16_bf16 v[64:79], v[48:51], v[144:147], v[64:79]
    v_mfma_f32_32x32x16_bf16 v[80:95], v[52:55], v[144:147], v[80:95]
    s_waitcnt lgkmcnt(8)
    ds_read_b64_tr_b16 v[48:49], v18 offset:16384
    ds_read_b64_tr_b16 v[50:51], v18 offset:16896
    ds_read_b64_tr_b16 v[52:53], v19 offset:16384
    ds_read_b64_tr_b16 v[54:55], v19 offset:16896
    v_mfma_f32_32x32x16_bf16 v[64:79], v[56:59], v[148:151], v[64:79]
    v_mfma_f32_32x32x16_bf16 v[80:95], v[60:63], v[148:151], v[80:95]
    s_waitcnt lgkmcnt(8)
    ds_read_b64_tr_b16 v[56:57], v18 offset:18432
    ds_read_b64_tr_b16 v[58:59], v18 offset:18944
    ds_read_b64_tr_b16 v[60:61], v19 offset:18432
    ds_read_b64_tr_b16 v[62:63], v19 offset:18944
    v_mfma_f32_32x32x16_bf16 v[64:79], v[240:243], v[152:155], v[64:79]
    v_mfma_f32_32x32x16_bf16 v[80:95], v[244:247], v[152:155], v[80:95]
    s_waitcnt lgkmcnt(8)
    ds_read_b64_tr_b16 v[240:241], v18 offset:20480
    ds_read_b64_tr_b16 v[242:243], v18 offset:20992
    ds_read_b64_tr_b16 v[244:245], v19 offset:20480
    ds_read_b64_tr_b16 v[246:247], v19 offset:20992
    v_mfma_f32_32x32x16_bf16 v[64:79], v[248:251], v[156:159], v[64:79]
    v_mfma_f32_32x32x16_bf16 v[80:95], v[252:255], v[156:159], v[80:95]
    s_waitcnt lgkmcnt(8)
    ds_read_b64_tr_b16 v[248:249], v18 offset:22528
    ds_read_b64_tr_b16 v[250:251], v18 offset:23040
    ds_read_b64_tr_b16 v[252:253], v19 offset:22528
    ds_read_b64_tr_b16 v[254:255], v19 offset:23040
    v_mfma_f32_32x32x16_bf16 v[64:79], v[48:51], v[160:163], v[64:79]
    v_mfma_f32_32x32x16_bf16 v[80:95], v[52:55], v[160:163], v[80:95]
    s_waitcnt lgkmcnt(8)
    ds_read_b64_tr_b16 v[48:49], v18 offset:24576
    ds_read_b64_tr_b16 v[50:51], v18 offset:25088
    ds_read_b64_tr_b16 v[52:53], v19 offset:24576
    ds_read_b64_tr_b16 v[54:55], v19 offset:25088
    v_mfma_f32_32x32x16_bf16 v[64:79], v[56:59], v[164:167], v[64:79]
    v_mfma_f32_32x32x16_bf16 v[80:95], v[60:63], v[164:167], v[80:95]
    s_waitcnt lgkmcnt(8)
    ds_read_b64_tr_b16 v[56:57], v18 offset:26624
    ds_read_b64_tr_b16 v[58:59], v18 offset:27136
    ds_read_b64_tr_b16 v[60:61], v19 offset:26624
    ds_read_b64_tr_b16 v[62:63], v19 offset:27136
    v_mfma_f32_32x32x16_bf16 v[64:79], v[240:243], v[168:171], v[64:79]
    v_mfma_f32_32x32x16_bf16 v[80:95], v[244:247], v[168:171], v[80:95]
    s_waitcnt lgkmcnt(8)
    ds_read_b64_tr_b16 v[240:241], v18 offset:28672
    ds_read_b64_tr_b16 v[242:243], v18 offset:29184
    ds_read_b64_tr_b16 v[244:245], v19 offset:28672
    ds_read_b64_tr_b16 v[246:247], v19 offset:29184
    v_mfma_f32_32x32x16_bf16 v[64:79], v[248:251], v[172:175], v[64:79]
    v_mfma_f32_32x32x16_bf16 v[80:95], v[252:255], v[172:175], v[80:95]
    s_waitcnt lgkmcnt(8)
    ds_read_b64_tr_b16 v[248:249], v18 offset:30720
    ds_read_b64_tr_b16 v[250:251], v18 offset:31232
    ds_read_b64_tr_b16 v[252:253], v19 offset:30720
    ds_read_b64_tr_b16 v[254:255], v19 offset:31232
    v_mfma_f32_32x32x16_bf16 v[64:79], v[48:51], v[176:179], v[64:79]
    v_mfma_f32_32x32x16_bf16 v[80:95], v[52:55], v[176:179], v[80:95]
    s_waitcnt lgkmcnt(8)
    ds_read_b64_tr_b16 v[48:49], v18 offset:32768
    ds_read_b64_tr_b16 v[50:51], v18 offset:33280
    ds_read_b64_tr_b16 v[52:53], v19 offset:32768
    ds_read_b64_tr_b16 v[54:55], v19 offset:33280
    v_mfma_f32_32x32x16_bf16 v[64:79], v[56:59], v[180:183], v[64:79]
    v_mfma_f32_32x32x16_bf16 v[80:95], v[60:63], v[180:183], v[80:95]
    s_waitcnt lgkmcnt(8)
    ds_read_b64_tr_b16 v[56:57], v18 offset:34816
    ds_read_b64_tr_b16 v[58:59], v18 offset:35328
    ds_read_b64_tr_b16 v[60:61], v19 offset:34816
    ds_read_b64_tr_b16 v[62:63], v19 offset:35328
    v_mfma_f32_32x32x16_bf16 v[64:79], v[240:243], v[184:187], v[64:79]
    v_mfma_f32_32x32x16_bf16 v[80:95], v[244:247], v[184:187], v[80:95]
    s_waitcnt lgkmcnt(8)
    ds_read_b64_tr_b16 v[240:241], v18 offset:36864
    ds_read_b64_tr_b16 v[242:243], v18 offset:37376
    ds_read_b64_tr_b16 v[244:245], v19 offset:36864
    ds_read_b64_tr_b16 v[246:247], v19 offset:37376
    v_mfma_f32_32x32x16_bf16 v[64:79], v[248:251], v[188:191], v[64:79]
    v_mfma_f32_32x32x16_bf16 v[80:95], v[252:255], v[188:191], v[80:95]
    s_waitcnt lgkmcnt(8)
    ds_read_b64_tr_b16 v[248:249], v18 offset:38912
    ds_read_b64_tr_b16 v[250:251], v18 offset:39424
    ds_read_b64_tr_b16 v[252:253], v19 offset:38912
    ds_read_b64_tr_b16 v[254:255], v19 offset:39424
    v_mfma_f32_32x32x16_bf16 v[64:79], v[48:51], v[192:195], v[64:79]
    v_mfma_f32_32x32x16_bf16 v[80:95], v[52:55], v[192:195], v[80:95]
    s_waitcnt lgkmcnt(8)
    ds_read_b64_tr_b16 v[48:49], v18 offset:40960
    ds_read_b64_tr_b16 v[50:51], v18 offset:41472
    ds_read_b64_tr_b16 v[52:53], v19 offset:40960
    ds_read_b64_tr_b16 v[54:55], v19 offset:41472
    v_mfma_f32_32x32x16_bf16 v[64:79], v[56:59], v[196:199], v[64:79]
    v_mfma_f32_32x32x16_bf16 v[80:95], v[60:63], v[196:199], v[80:95]
    s_waitcnt lgkmcnt(8)
    ds_read_b64_tr_b16 v[56:57], v18 offset:43008
    ds_read_b64_tr_b16 v[58:59], v18 offset:43520
    ds_read_b64_tr_b16 v[60:61], v19 offset:43008
    ds_read_b64_tr_b16 v[62:63], v19 offset:43520
    v_mfma_f32_32x32x16_bf16 v[64:79], v[240:243], v[200:203], v[64:79]
    v_mfma_f32_32x32x16_bf16 v[80:95], v[244:247], v[200:203], v[80:95]
    s_waitcnt lgkmcnt(8)
    ds_read_b64_tr_b16 v[240:241], v18 offset:45056
    ds_read_b64_tr_b16 v[242:243], v18 offset:45568
    ds_read_b64_tr_b16 v[244:245], v19 offset:45056
    ds_read_b64_tr_b16 v[246:247], v19 offset:45568
    v_mfma_f32_32x32x16_bf16 v[64:79], v[248:251], v[204:207], v[64:79]
    v_mfma_f32_32x32x16_bf16 v[80:95], v[252:255], v[204:207], v[80:95]
    s_waitcnt lgkmcnt(8)
    ds_read_b64_tr_b16 v[248:249], v18 offset:47104
    ds_read_b64_tr_b16 v[250:251], v18 offset:47616
    ds_read_b64_tr_b16 v[252:253], v19 offset:47104
    ds_read_b64_tr_b16 v[254:255], v19 offset:47616
    v_mfma_f32_32x32x16_bf16 v[64:79], v[48:51], v[208:211], v[64:79]
    v_mfma_f32_32x32x16_bf16 v[80:95], v[52:55], v[208:211], v[80:95]
    ds_read_b32 v29, v27 offset:12
    s_waitcnt lgkmcnt(9)
    ds_read_b64_tr_b16 v[48:49], v18 offset:49152
    ds_read_b64_tr_b16 v[50:51], v18 offset:49664
    ds_read_b64_tr_b16 v[52:53], v19 offset:49152
    ds_read_b64_tr_b16 v[54:55], v19 offset:49664
    v_mfma_f32_32x32x16_bf16 v[64:79], v[56:59], v[212:215], v[64:79]
    v_mfma_f32_32x32x16_bf16 v[80:95], v[60:63], v[212:215], v[80:95]
    s_waitcnt lgkmcnt(9)
    ds_read_b64_tr_b16 v[56:57], v18 offset:51200
    ds_read_b64_tr_b16 v[58:59], v18 offset:51712
    ds_read_b64_tr_b16 v[60:61], v19 offset:51200
    ds_read_b64_tr_b16 v[62:63], v19 offset:51712
    v_mfma_f32_32x32x16_bf16 v[64:79], v[240:243], v[216:219], v[64:79]
    v_mfma_f32_32x32x16_bf16 v[80:95], v[244:247], v[216:219], v[80:95]
    s_waitcnt lgkmcnt(9)
    ds_read_b64_tr_b16 v[240:241], v18 offset:53248
    ds_read_b64_tr_b16 v[242:243], v18 offset:53760
    ds_read_b64_tr_b16 v[244:245], v19 offset:53248
    ds_read_b64_tr_b16 v[246:247], v19 offset:53760
    v_mfma_f32_32x32x16_bf16 v[64:79], v[248:251], v[220:223], v[64:79]
    v_mfma_f32_32x32x16_bf16 v[80:95], v[252:255], v[220:223], v[80:95]
    s_waitcnt lgkmcnt(8)
    ds_read_b64_tr_b16 v[248:249], v18 offset:55296
    ds_read_b64_tr_b16 v[250:251], v18 offset:55808
    ds_read_b64_tr_b16 v[252:253], v19 offset:55296
    ds_read_b64_tr_b16 v[254:255], v19 offset:55808
    v_mfma_f32_32x32x16_bf16 v[64:79], v[48:51], v[224:227], v[64:79]
    v_mfma_f32_32x32x16_bf16 v[80:95], v[52:55], v[224:227], v[80:95]
    s_waitcnt lgkmcnt(14)
    v_readfirstlane_b32 s97, v29
    s_nop 0
    s_cmp_lt_u32 s97, 4
    s_cbranch_scc1 AC_2
AC_2_r:
    s_waitcnt lgkmcnt(8)
    ds_read_b64_tr_b16 v[48:49], v20 offset:0
    ds_read_b64_tr_b16 v[50:51], v20 offset:256
    ds_read_b64_tr_b16 v[52:53], v20 offset:1024
    ds_read_b64_tr_b16 v[54:55], v20 offset:1280
    v_mfma_f32_32x32x16_bf16 v[64:79], v[56:59], v[228:231], v[64:79]
    v_mfma_f32_32x32x16_bf16 v[80:95], v[60:63], v[228:231], v[80:95]
    s_waitcnt lgkmcnt(8)
    ds_read_b64_tr_b16 v[56:57], v20 offset:2048
    ds_read_b64_tr_b16 v[58:59], v20 offset:2304
    ds_read_b64_tr_b16 v[60:61], v20 offset:3072
    ds_read_b64_tr_b16 v[62:63], v20 offset:3328
    v_mfma_f32_32x32x16_bf16 v[64:79], v[240:243], v[232:235], v[64:79]
    v_mfma_f32_32x32x16_bf16 v[80:95], v[244:247], v[232:235], v[80:95]
    s_waitcnt lgkmcnt(8)
    ds_read_b64_tr_b16 v[240:241], v20 offset:4096
    ds_read_b64_tr_b16 v[242:243], v20 offset:4352
    ds_read_b64_tr_b16 v[244:245], v20 offset:5120
    ds_read_b64_tr_b16 v[246:247], v20 offset:5376
    s_mov_b64 exec, 1
    ds_add_u32 v27, v30 offset:28
    s_mov_b64 exec, -1
    v_mfma_f32_32x32x16_bf16 v[64:79], v[248:251], v[236:239], v[64:79]
    v_mfma_f32_32x32x16_bf16 v[80:95], v[252:255], v[236:239], v[80:95]
    s_waitcnt lgkmcnt(9)
    ds_read_b64_tr_b16 v[248:249], v20 offset:6144
    ds_read_b64_tr_b16 v[250:251], v20 offset:6400
    ds_read_b64_tr_b16 v[252:253], v20 offset:7168
    ds_read_b64_tr_b16 v[254:255], v20 offset:7424
    v_mfma_f32_32x32x16_bf16 v[96:111], v[48:51], v[128:131], 0
    v_mfma_f32_32x32x16_bf16 v[96:111], v[52:55], v[132:135], v[96:111]
    s_waitcnt lgkmcnt(9)
    ds_read_b64_tr_b16 v[48:49], v20 offset:8192
    ds_read_b64_tr_b16 v[50:51], v20 offset:8448
    ds_read_b64_tr_b16 v[52:53], v20 offset:9216
    ds_read_b64_tr_b16 v[54:55], v20 offset:9472
    v_mfma_f32_32x32x16_bf16 v[96:111], v[56:59], v[136:139], v[96:111]
    v_mfma_f32_32x32x16_bf16 v[96:111], v[60:63], v[140:143], v[96:111]
    v_mul_f32 v64, v64, v3
    v_mul_f32 v65, v65, v3
    s_waitcnt lgkmcnt(9)
    ds_read_b64_tr_b16 v[56:57], v20 offset:10240
    ds_read_b64_tr_b16 v[58:59], v20 offset:10496
    ds_read_b64_tr_b16 v[60:61], v20 offset:11264
    ds_read_b64_tr_b16 v[62:63], v20 offset:11520
    v_mfma_f32_32x32x16_bf16 v[96:111], v[240:243], v[144:147], v[96:111]
    v_mul_f32 v66, v66, v3
    v_mul_f32 v67, v67, v3
    v_mfma_f32_32x32x16_bf16 v[96:111], v[244:247], v[148:151], v[96:111]
    v_cvt_pk_bf16_f32 v64, v64, v65
    v_cvt_pk_bf16_f32 v65, v66, v67
    buffer_store_dwordx2 v[64:65], v21, s[24:27], s68 offen offset:0 sc1
    s_waitcnt lgkmcnt(8)
    ds_read_b64_tr_b16 v[240:241], v20 offset:12288
    ds_read_b64_tr_b16 v[242:243], v20 offset:12544
    ds_read_b64_tr_b16 v[244:245], v20 offset:13312
    ds_read_b64_tr_b16 v[246:247], v20 offset:13568
    v_mfma_f32_32x32x16_bf16 v[96:111], v[248:251], v[152:155], v[96:111]
    v_mul_f32 v68, v68, v3
    v_mul_f32 v69, v69, v3
    v_mfma_f32_32x32x16_bf16 v[96:111], v[252:255], v[156:159], v[96:111]
    v_mul_f32 v70, v70, v3
    v_mul_f32 v71, v71, v3
    v_cvt_pk_bf16_f32 v68, v68, v69
    s_waitcnt lgkmcnt(8)
    ds_read_b64_tr_b16 v[248:249], v20 offset:14336
    ds_read_b64_tr_b16 v[250:251], v20 offset:14592
    ds_read_b64_tr_b16 v[252:253], v20 offset:15360
    ds_read_b64_tr_b16 v[254:255], v20 offset:15616
    v_mfma_f32_32x32x16_bf16 v[96:111], v[48:51], v[160:163], v[96:111]
    v_cvt_pk_bf16_f32 v69, v70, v71
    buffer_store_dwordx2 v[68:69], v21, s[24:27], s68 offen offset:512 sc1
    v_mfma_f32_32x32x16_bf16 v[96:111], v[52:55], v[164:167], v[96:111]
    v_mul_f32 v72, v72, v3
    v_mul_f32 v73, v73, v3
    v_mul_f32 v74, v74, v3
    s_waitcnt lgkmcnt(8)
    ds_read_b64_tr_b16 v[48:49], v20 offset:16384
    ds_read_b64_tr_b16 v[50:51], v20 offset:16640
    ds_read_b64_tr_b16 v[52:53], v20 offset:17408
    ds_read_b64_tr_b16 v[54:55], v20 offset:17664
    v_mfma_f32_32x32x16_bf16 v[96:111], v[56:59], v[168:171], v[96:111]
    v_mul_f32 v75, v75, v3
    v_cvt_pk_bf16_f32 v72, v72, v73
    v_mfma_f32_32x32x16_bf16 v[96:111], v[60:63], v[172:175], v[96:111]
    v_cvt_pk_bf16_f32 v73, v74, v75
    buffer_store_dwordx2 v[72:73], v21, s[24:27], s68 offen offset:1024 sc1
    s_waitcnt lgkmcnt(8)
    ds_read_b64_tr_b16 v[56:57], v20 offset:18432
    ds_read_b64_tr_b16 v[58:59], v20 offset:18688
    ds_read_b64_tr_b16 v[60:61], v20 offset:19456
    ds_read_b64_tr_b16 v[62:63], v20 offset:19712
    v_mfma_f32_32x32x16_bf16 v[96:111], v[240:243], v[176:179], v[96:111]
    v_mul_f32 v76, v76, v3
    v_mul_f32 v77, v77, v3
    v_mul_f32 v78, v78, v3
    v_mfma_f32_32x32x16_bf16 v[96:111], v[244:247], v[180:183], v[96:111]
    v_mul_f32 v79, v79, v3
    v_cvt_pk_bf16_f32 v76, v76, v77
    ds_read_b32 v29, v27 offset:16
    s_waitcnt lgkmcnt(9)
    ds_read_b64_tr_b16 v[240:241], v20 offset:20480
    ds_read_b64_tr_b16 v[242:243], v20 offset:20736
    ds_read_b64_tr_b16 v[244:245], v20 offset:21504
    ds_read_b64_tr_b16 v[246:247], v20 offset:21760
    v_mfma_f32_32x32x16_bf16 v[96:111], v[248:251], v[184:187], v[96:111]
    v_cvt_pk_bf16_f32 v77, v78, v79
    buffer_store_dwordx2 v[76:77], v21, s[24:27], s68 offen offset:1536 sc1
    v_mul_f32 v80, v80, v3
    v_mfma_f32_32x32x16_bf16 v[96:111], v[252:255], v[188:191], v[96:111]
    v_mul_f32 v81, v81, v3
    v_mul_f32 v82, v82, v3
    s_waitcnt lgkmcnt(9)
    ds_read_b64_tr_b16 v[248:249], v20 offset:22528
    ds_read_b64_tr_b16 v[250:251], v20 offset:22784
    ds_read_b64_tr_b16 v[252:253], v20 offset:23552
    ds_read_b64_tr_b16 v[254:255], v20 offset:23808
    v_mfma_f32_32x32x16_bf16 v[96:111], v[48:51], v[192:195], v[96:111]
    v_mul_f32 v83, v83, v3
    v_cvt_pk_bf16_f32 v80, v80, v81
    v_cvt_pk_bf16_f32 v81, v82, v83
    v_mfma_f32_32x32x16_bf16 v[96:111], v[52:55], v[196:199], v[96:111]
    buffer_store_dwordx2 v[80:81], v21, s[24:27], s68 offen offset:2048 sc1
    v_mul_f32 v84, v84, v3
    s_waitcnt lgkmcnt(9)
    ds_read_b64_tr_b16 v[48:49], v20 offset:24576
    ds_read_b64_tr_b16 v[50:51], v20 offset:24832
    ds_read_b64_tr_b16 v[52:53], v20 offset:25600
    ds_read_b64_tr_b16 v[54:55], v20 offset:25856
    v_mfma_f32_32x32x16_bf16 v[96:111], v[56:59], v[200:203], v[96:111]
    v_mul_f32 v85, v85, v3
    v_mul_f32 v86, v86, v3
    v_mfma_f32_32x32x16_bf16 v[96:111], v[60:63], v[204:207], v[96:111]
    v_mul_f32 v87, v87, v3
    v_cvt_pk_bf16_f32 v84, v84, v85
    v_cvt_pk_bf16_f32 v85, v86, v87
    s_waitcnt lgkmcnt(8)
    ds_read_b64_tr_b16 v[56:57], v20 offset:26624
    ds_read_b64_tr_b16 v[58:59], v20 offset:26880
    ds_read_b64_tr_b16 v[60:61], v20 offset:27648
    ds_read_b64_tr_b16 v[62:63], v20 offset:27904
    v_mfma_f32_32x32x16_bf16 v[96:111], v[240:243], v[208:211], v[96:111]
    buffer_store_dwordx2 v[84:85], v21, s[24:27], s68 offen offset:2560 sc1
    v_mul_f32 v88, v88, v3
    v_mfma_f32_32x32x16_bf16 v[96:111], v[244:247], v[212:215], v[96:111]
    v_mul_f32 v89, v89, v3
    v_mul_f32 v90, v90, v3
    v_mul_f32 v91, v91, v3
    s_waitcnt lgkmcnt(14)
    v_readfirstlane_b32 s97, v29
    s_nop 0
    s_cmp_lt_u32 s97, 4
    s_cbranch_scc1 AC_3
AC_3_r:
    s_waitcnt lgkmcnt(8)
    ds_read_b64_tr_b16 v[240:241], v16 offset:0
    ds_read_b64_tr_b16 v[242:243], v16 offset:512
    ds_read_b64_tr_b16 v[244:245], v17 offset:0
    ds_read_b64_tr_b16 v[246:247], v17 offset:512
    v_mfma_f32_32x32x16_bf16 v[96:111], v[248:251], v[216:219], v[96:111]
    v_cvt_pk_bf16_f32 v88, v88, v89
    v_cvt_pk_bf16_f32 v89, v90, v91
    v_mfma_f32_32x32x16_bf16 v[96:111], v[252:255], v[220:223], v[96:111]
    buffer_store_dwordx2 v[88:89], v21, s[24:27], s68 offen offset:3072 sc1
    v_mul_f32 v92, v92, v3
    v_mul_f32 v93, v93, v3
    s_waitcnt lgkmcnt(8)
    ds_read_b64_tr_b16 v[248:249], v16 offset:2048
    ds_read_b64_tr_b16 v[250:251], v16 offset:2560
    ds_read_b64_tr_b16 v[252:253], v17 offset:2048
    ds_read_b64_tr_b16 v[254:255], v17 offset:2560
    v_mfma_f32_32x32x16_bf16 v[96:111], v[48:51], v[224:227], v[96:111]
    v_mul_f32 v94, v94, v3
    v_mul_f32 v95, v95, v3
    v_mfma_f32_32x32x16_bf16 v[96:111], v[52:55], v[228:231], v[96:111]
    v_cvt_pk_bf16_f32 v92, v92, v93
    v_cvt_pk_bf16_f32 v93, v94, v95
    buffer_store_dwordx2 v[92:93], v21, s[24:27], s68 offen offset:3584 sc1
    s_waitcnt lgkmcnt(8)
    ds_read_b64_tr_b16 v[48:49], v16 offset:4096
    ds_read_b64_tr_b16 v[50:51], v16 offset:4608
    ds_read_b64_tr_b16 v[52:53], v17 offset:4096
    ds_read_b64_tr_b16 v[54:55], v17 offset:4608
    s_mov_b64 exec, 1
    ds_add_u32 v27, v30 offset:32
    s_mov_b64 exec, -1
    v_mfma_f32_32x32x16_bf16 v[96:111], v[56:59], v[232:235], v[96:111]
    v_mfma_f32_32x32x16_bf16 v[96:111], v[60:63], v[236:239], v[96:111]
    s_waitcnt lgkmcnt(9)
    ds_read_b64_tr_b16 v[56:57], v16 offset:6144
    ds_read_b64_tr_b16 v[58:59], v16 offset:6656
    ds_read_b64_tr_b16 v[60:61], v17 offset:6144
    ds_read_b64_tr_b16 v[62:63], v17 offset:6656
    v_mfma_f32_32x32x16_bf16 v[64:79], v[240:243], v[128:131], 0
    v_mfma_f32_32x32x16_bf16 v[80:95], v[244:247], v[128:131], 0
    s_waitcnt lgkmcnt(9)
    ds_read_b64_tr_b16 v[240:241], v16 offset:8192
    ds_read_b64_tr_b16 v[242:243], v16 offset:8704
    ds_read_b64_tr_b16 v[244:245], v17 offset:8192
    ds_read_b64_tr_b16 v[246:247], v17 offset:8704
    v_mfma_f32_32x32x16_bf16 v[64:79], v[248:251], v[132:135], v[64:79]
    v_mfma_f32_32x32x16_bf16 v[80:95], v[252:255], v[132:135], v[80:95]
    v_mul_f32 v96, v96, v2
    v_mul_f32 v97, v97, v2
    v_mul_f32 v98, v98, v2
    v_mul_f32 v99, v99, v2
    s_waitcnt lgkmcnt(9)
    ds_read_b64_tr_b16 v[248:249], v16 offset:10240
    ds_read_b64_tr_b16 v[250:251], v16 offset:10752
    ds_read_b64_tr_b16 v[252:253], v17 offset:10240
    ds_read_b64_tr_b16 v[254:255], v17 offset:10752
    v_mfma_f32_32x32x16_bf16 v[64:79], v[48:51], v[136:139], v[64:79]
    v_cvt_pk_bf16_f32 v96, v96, v97
    v_cvt_pk_bf16_f32 v97, v98, v99
    buffer_store_dwordx2 v[96:97], v21, s[24:27], s67 offen offset:0 sc1
    v_mul_f32 v100, v100, v2
    v_mfma_f32_32x32x16_bf16 v[80:95], v[52:55], v[136:139], v[80:95]
    v_mul_f32 v101, v101, v2
    v_mul_f32 v102, v102, v2
    v_mul_f32 v103, v103, v2
    v_cvt_pk_bf16_f32 v100, v100, v101
    s_waitcnt lgkmcnt(8)
    ds_read_b64_tr_b16 v[48:49], v16 offset:12288
    ds_read_b64_tr_b16 v[50:51], v16 offset:12800
    ds_read_b64_tr_b16 v[52:53], v17 offset:12288
    ds_read_b64_tr_b16 v[54:55], v17 offset:12800
    v_mfma_f32_32x32x16_bf16 v[64:79], v[56:59], v[140:143], v[64:79]
    v_cvt_pk_bf16_f32 v101, v102, v103
    buffer_store_dwordx2 v[100:101], v21, s[24:27], s67 offen offset:512 sc1
    v_mul_f32 v104, v104, v2
    v_mul_f32 v105, v105, v2
    v_mfma_f32_32x32x16_bf16 v[80:95], v[60:63], v[140:143], v[80:95]
    v_mul_f32 v106, v106, v2
    v_mul_f32 v107, v107, v2
    v_cvt_pk_bf16_f32 v104, v104, v105
    v_cvt_pk_bf16_f32 v105, v106, v107
    s_waitcnt lgkmcnt(8)
    ds_read_b64_tr_b16 v[56:57], v16 offset:14336
    ds_read_b64_tr_b16 v[58:59], v16 offset:14848
    ds_read_b64_tr_b16 v[60:61], v17 offset:14336
    ds_read_b64_tr_b16 v[62:63], v17 offset:14848
    v_mfma_f32_32x32x16_bf16 v[64:79], v[240:243], v[144:147], v[64:79]
    buffer_store_dwordx2 v[104:105], v21, s[24:27], s67 offen offset:1024 sc1
    v_mul_f32 v108, v108, v2
    v_mul_f32 v109, v109, v2
    v_mul_f32 v110, v110, v2
    v_mfma_f32_32x32x16_bf16 v[80:95], v[244:247], v[144:147], v[80:95]
    v_mul_f32 v111, v111, v2
    v_cvt_pk_bf16_f32 v108, v108, v109
    v_cvt_pk_bf16_f32 v109, v110, v111
    buffer_store_dwordx2 v[108:109], v21, s[24:27], s67 offen offset:1536 sc1
    s_waitcnt lgkmcnt(8)
    ds_read_b64_tr_b16 v[240:241], v16 offset:16384
    ds_read_b64_tr_b16 v[242:243], v16 offset:16896
    ds_read_b64_tr_b16 v[244:245], v17 offset:16384
    ds_read_b64_tr_b16 v[246:247], v17 offset:16896
    v_mfma_f32_32x32x16_bf16 v[64:79], v[248:251], v[148:151], v[64:79]
    v_mfma_f32_32x32x16_bf16 v[80:95], v[252:255], v[148:151], v[80:95]
    s_waitcnt lgkmcnt(8)
    ds_read_b64_tr_b16 v[248:249], v16 offset:18432
    ds_read_b64_tr_b16 v[250:251], v16 offset:18944
    ds_read_b64_tr_b16 v[252:253], v17 offset:18432
    ds_read_b64_tr_b16 v[254:255], v17 offset:18944
    v_mfma_f32_32x32x16_bf16 v[64:79], v[48:51], v[152:155], v[64:79]
    v_mfma_f32_32x32x16_bf16 v[80:95], v[52:55], v[152:155], v[80:95]
    s_waitcnt lgkmcnt(8)
    ds_read_b64_tr_b16 v[48:49], v16 offset:20480
    ds_read_b64_tr_b16 v[50:51], v16 offset:20992
    ds_read_b64_tr_b16 v[52:53], v17 offset:20480
    ds_read_b64_tr_b16 v[54:55], v17 offset:20992
    v_mfma_f32_32x32x16_bf16 v[64:79], v[56:59], v[156:159], v[64:79]
    v_mfma_f32_32x32x16_bf16 v[80:95], v[60:63], v[156:159], v[80:95]
    s_waitcnt lgkmcnt(8)
    ds_read_b64_tr_b16 v[56:57], v16 offset:22528
    ds_read_b64_tr_b16 v[58:59], v16 offset:23040
    ds_read_b64_tr_b16 v[60:61], v17 offset:22528
    ds_read_b64_tr_b16 v[62:63], v17 offset:23040
    v_mfma_f32_32x32x16_bf16 v[64:79], v[240:243], v[160:163], v[64:79]
    v_mfma_f32_32x32x16_bf16 v[80:95], v[244:247], v[160:163], v[80:95]
    s_waitcnt lgkmcnt(8)
    ds_read_b64_tr_b16 v[240:241], v16 offset:24576
    ds_read_b64_tr_b16 v[242:243], v16 offset:25088
    ds_read_b64_tr_b16 v[244:245], v17 offset:24576
    ds_read_b64_tr_b16 v[246:247], v17 offset:25088
    v_mfma_f32_32x32x16_bf16 v[64:79], v[248:251], v[164:167], v[64:79]
    v_mfma_f32_32x32x16_bf16 v[80:95], v[252:255], v[164:167], v[80:95]
    s_waitcnt lgkmcnt(8)
    ds_read_b64_tr_b16 v[248:249], v16 offset:26624
    ds_read_b64_tr_b16 v[250:251], v16 offset:27136
    ds_read_b64_tr_b16 v[252:253], v17 offset:26624
    ds_read_b64_tr_b16 v[254:255], v17 offset:27136
    v_mfma_f32_32x32x16_bf16 v[64:79], v[48:51], v[168:171], v[64:79]
    v_mfma_f32_32x32x16_bf16 v[80:95], v[52:55], v[168:171], v[80:95]
    s_waitcnt lgkmcnt(8)
    ds_read_b64_tr_b16 v[48:49], v16 offset:28672
    ds_read_b64_tr_b16 v[50:51], v16 offset:29184
    ds_read_b64_tr_b16 v[52:53], v17 offset:28672
    ds_read_b64_tr_b16 v[54:55], v17 offset:29184
    v_mfma_f32_32x32x16_bf16 v[64:79], v[56:59], v[172:175], v[64:79]
    v_mfma_f32_32x32x16_bf16 v[80:95], v[60:63], v[172:175], v[80:95]
    s_waitcnt lgkmcnt(8)
    ds_read_b64_tr_b16 v[56:57], v16 offset:30720
    ds_read_b64_tr_b16 v[58:59], v16 offset:31232
    ds_read_b64_tr_b16 v[60:61], v17 offset:30720
    ds_read_b64_tr_b16 v[62:63], v17 offset:31232
    v_mfma_f32_32x32x16_bf16 v[64:79], v[240:243], v[176:179], v[64:79]
    v_mfma_f32_32x32x16_bf16 v[80:95], v[244:247], v[176:179], v[80:95]
    s_waitcnt lgkmcnt(8)
    ds_read_b64_tr_b16 v[240:241], v16 offset:32768
    ds_read_b64_tr_b16 v[242:243], v16 offset:33280
    ds_read_b64_tr_b16 v[244:245], v17 offset:32768
    ds_read_b64_tr_b16 v[246:247], v17 offset:33280
    v_mfma_f32_32x32x16_bf16 v[64:79], v[248:251], v[180:183], v[64:79]
    v_mfma_f32_32x32x16_bf16 v[80:95], v[252:255], v[180:183], v[80:95]
    s_waitcnt lgkmcnt(8)
    ds_read_b64_tr_b16 v[248:249], v16 offset:34816
    ds_read_b64_tr_b16 v[250:251], v16 offset:35328
    ds_read_b64_tr_b16 v[252:253], v17 offset:34816
    ds_read_b64_tr_b16 v[254:255], v17 offset:35328
    v_mfma_f32_32x32x16_bf16 v[64:79], v[48:51], v[184:187], v[64:79]
    v_mfma_f32_32x32x16_bf16 v[80:95], v[52:55], v[184:187], v[80:95]
    s_waitcnt lgkmcnt(8)
    ds_read_b64_tr_b16 v[48:49], v16 offset:36864
    ds_read_b64_tr_b16 v[50:51], v16 offset:37376
    ds_read_b64_tr_b16 v[52:53], v17 offset:36864
    ds_read_b64_tr_b16 v[54:55], v17 offset:37376
    v_mfma_f32_32x32x16_bf16 v[64:79], v[56:59], v[188:191], v[64:79]
    v_mfma_f32_32x32x16_bf16 v[80:95], v[60:63], v[188:191], v[80:95]
    s_waitcnt lgkmcnt(8)
    ds_read_b64_tr_b16 v[56:57], v16 offset:38912
    ds_read_b64_tr_b16 v[58:59], v16 offset:39424
    ds_read_b64_tr_b16 v[60:61], v17 offset:38912
    ds_read_b64_tr_b16 v[62:63], v17 offset:39424
    v_mfma_f32_32x32x16_bf16 v[64:79], v[240:243], v[192:195], v[64:79]
    v_mfma_f32_32x32x16_bf16 v[80:95], v[244:247], v[192:195], v[80:95]
    s_waitcnt lgkmcnt(8)
    ds_read_b64_tr_b16 v[240:241], v16 offset:40960
    ds_read_b64_tr_b16 v[242:243], v16 offset:41472
    ds_read_b64_tr_b16 v[244:245], v17 offset:40960
    ds_read_b64_tr_b16 v[246:247], v17 offset:41472
    v_mfma_f32_32x32x16_bf16 v[64:79], v[248:251], v[196:199], v[64:79]
    v_mfma_f32_32x32x16_bf16 v[80:95], v[252:255], v[196:199], v[80:95]
    s_waitcnt lgkmcnt(8)
    ds_read_b64_tr_b16 v[248:249], v16 offset:43008
    ds_read_b64_tr_b16 v[250:251], v16 offset:43520
    ds_read_b64_tr_b16 v[252:253], v17 offset:43008
    ds_read_b64_tr_b16 v[254:255], v17 offset:43520
    v_mfma_f32_32x32x16_bf16 v[64:79], v[48:51], v[200:203], v[64:79]
    v_mfma_f32_32x32x16_bf16 v[80:95], v[52:55], v[200:203], v[80:95]
    s_waitcnt lgkmcnt(8)
    ds_read_b64_tr_b16 v[48:49], v16 offset:45056
    ds_read_b64_tr_b16 v[50:51], v16 offset:45568
    ds_read_b64_tr_b16 v[52:53], v17 offset:45056
    ds_read_b64_tr_b16 v[54:55], v17 offset:45568
    v_mfma_f32_32x32x16_bf16 v[64:79], v[56:59], v[204:207], v[64:79]
    v_mfma_f32_32x32x16_bf16 v[80:95], v[60:63], v[204:207], v[80:95]
    s_waitcnt lgkmcnt(8)
    ds_read_b64_tr_b16 v[56:57], v16 offset:47104
    ds_read_b64_tr_b16 v[58:59], v16 offset:47616
    ds_read_b64_tr_b16 v[60:61], v17 offset:47104
    ds_read_b64_tr_b16 v[62:63], v17 offset:47616
    v_mfma_f32_32x32x16_bf16 v[64:79], v[240:243], v[208:211], v[64:79]
    v_mfma_f32_32x32x16_bf16 v[80:95], v[244:247], v[208:211], v[80:95]
    ds_read_b32 v29, v27 offset:20
    s_waitcnt lgkmcnt(9)
    ds_read_b64_tr_b16 v[240:241], v16 offset:49152
    ds_read_b64_tr_b16 v[242:243], v16 offset:49664
    ds_read_b64_tr_b16 v[244:245], v17 offset:49152
    ds_read_b64_tr_b16 v[246:247], v17 offset:49664
    v_mfma_f32_32x32x16_bf16 v[64:79], v[248:251], v[212:215], v[64:79]
    v_mfma_f32_32x32x16_bf16 v[80:95], v[252:255], v[212:215], v[80:95]
    s_waitcnt lgkmcnt(9)
    ds_read_b64_tr_b16 v[248:249], v16 offset:51200
    ds_read_b64_tr_b16 v[250:251], v16 offset:51712
    ds_read_b64_tr_b16 v[252:253], v17 offset:51200
    ds_read_b64_tr_b16 v[254:255], v17 offset:51712
    v_mfma_f32_32x32x16_bf16 v[64:79], v[48:51], v[216:219], v[64:79]
    v_mfma_f32_32x32x16_bf16 v[80:95], v[52:55], v[216:219], v[80:95]
    s_waitcnt lgkmcnt(9)
    ds_read_b64_tr_b16 v[48:49], v16 offset:53248
    ds_read_b64_tr_b16 v[50:51], v16 offset:53760
    ds_read_b64_tr_b16 v[52:53], v17 offset:53248
    ds_read_b64_tr_b16 v[54:55], v17 offset:53760
    v_mfma_f32_32x32x16_bf16 v[64:79], v[56:59], v[220:223], v[64:79]
    v_mfma_f32_32x32x16_bf16 v[80:95], v[60:63], v[220:223], v[80:95]
    s_waitcnt lgkmcnt(8)
    ds_read_b64_tr_b16 v[56:57], v16 offset:55296
    ds_read_b64_tr_b16 v[58:59], v16 offset:55808
    ds_read_b64_tr_b16 v[60:61], v17 offset:55296
    ds_read_b64_tr_b16 v[62:63], v17 offset:55808
    v_mfma_f32_32x32x16_bf16 v[64:79], v[240:243], v[224:227], v[64:79]
    v_mfma_f32_32x32x16_bf16 v[80:95], v[244:247], v[224:227], v[80:95]
    s_waitcnt lgkmcnt(14)
    v_readfirstlane_b32 s97, v29
    s_nop 0
    s_cmp_lt_u32 s97, 4
    s_cbranch_scc1 AC_5
AC_5_r:
    s_waitcnt lgkmcnt(8)
    ds_read_b64_tr_b16 v[240:241], v18 offset:0
    ds_read_b64_tr_b16 v[242:243], v18 offset:512
    ds_read_b64_tr_b16 v[244:245], v19 offset:0
    ds_read_b64_tr_b16 v[246:247], v19 offset:512
    v_mfma_f32_32x32x16_bf16 v[64:79], v[248:251], v[228:231], v[64:79]
    s_waitcnt vmcnt(0)
    s_mov_b64 exec, 1
    ds_add_rtn_u32 v4, v27, v30 offset:48
    s_mov_b64 exec, -1
    v_mfma_f32_32x32x16_bf16 v[80:95], v[252:255], v[228:231], v[80:95]
    s_waitcnt lgkmcnt(9)
    ds_read_b64_tr_b16 v[248:249], v18 offset:2048
    ds_read_b64_tr_b16 v[250:251], v18 offset:2560
    ds_read_b64_tr_b16 v[252:253], v19 offset:2048
    ds_read_b64_tr_b16 v[254:255], v19 offset:2560
    v_mfma_f32_32x32x16_bf16 v[64:79], v[48:51], v[232:235], v[64:79]
    v_mfma_f32_32x32x16_bf16 v[80:95], v[52:55], v[232:235], v[80:95]
    s_waitcnt lgkmcnt(9)
    ds_read_b64_tr_b16 v[48:49], v18 offset:4096
    ds_read_b64_tr_b16 v[50:51], v18 offset:4608
    ds_read_b64_tr_b16 v[52:53], v19 offset:4096
    ds_read_b64_tr_b16 v[54:55], v19 offset:4608
    s_mov_b64 exec, 1
    ds_add_u32 v27, v30 offset:36
    s_mov_b64 exec, -1
    v_mfma_f32_32x32x16_bf16 v[64:79], v[56:59], v[236:239], v[64:79]
    s_waitcnt lgkmcnt(9)
    v_readfirstlane_b32 s97, v4
    s_nop 0
    s_cmp_lg_u32 s97, 3
    s_cbranch_scc1 FG_4
    s_mov_b64 exec, 1
    buffer_store_dword v6, v5, s[24:27], s75 offen sc1
    s_mov_b64 exec, -1
FG_4:
    v_mfma_f32_32x32x16_bf16 v[80:95], v[60:63], v[236:239], v[80:95]
    s_branch A_join
A_pb:
    ds_read_b64_tr_b16 v[48:49], v18 offset:0
    ds_read_b64_tr_b16 v[50:51], v18 offset:512
    ds_read_b64_tr_b16 v[52:53], v19 offset:0
    ds_read_b64_tr_b16 v[54:55], v19 offset:512
    ds_read_b64_tr_b16 v[56:57], v18 offset:2048
    ds_read_b64_tr_b16 v[58:59], v18 offset:2560
    ds_read_b64_tr_b16 v[60:61], v19 offset:2048
    ds_read_b64_tr_b16 v[62:63], v19 offset:2560
    ds_read_b64_tr_b16 v[240:241], v18 offset:4096
    ds_read_b64_tr_b16 v[242:243], v18 offset:4608
    ds_read_b64_tr_b16 v[244:245], v19 offset:4096
    ds_read_b64_tr_b16 v[246:247], v19 offset:4608
    s_waitcnt lgkmcnt(8)
    ds_read_b64_tr_b16 v[248:249], v18 offset:6144
    ds_read_b64_tr_b16 v[250:251], v18 offset:6656
    ds_read_b64_tr_b16 v[252:253], v19 offset:6144
    ds_read_b64_tr_b16 v[254:255], v19 offset:6656
    v_mfma_f32_32x32x16_bf16 v[64:79], v[128:131], v[48:51], 0
    v_mfma_f32_32x32x16_bf16 v[80:95], v[128:131], v[52:55], 0
    s_waitcnt lgkmcnt(8)
    ds_read_b64_tr_b16 v[48:49], v18 offset:8192
    ds_read_b64_tr_b16 v[50:51], v18 offset:8704
    ds_read_b64_tr_b16 v[52:53], v19 offset:8192
    ds_read_b64_tr_b16 v[54:55], v19 offset:8704
    v_mfma_f32_32x32x16_bf16 v[64:79], v[132:135], v[56:59], v[64:79]
    v_mfma_f32_32x32x16_bf16 v[80:95], v[132:135], v[60:63], v[80:95]
    s_waitcnt lgkmcnt(8)
    ds_read_b64_tr_b16 v[56:57], v18 offset:10240
    ds_read_b64_tr_b16 v[58:59], v18 offset:10752
    ds_read_b64_tr_b16 v[60:61], v19 offset:10240
    ds_read_b64_tr_b16 v[62:63], v19 offset:10752
    v_mfma_f32_32x32x16_bf16 v[64:79], v[136:139], v[240:243], v[64:79]
    v_mfma_f32_32x32x16_bf16 v[80:95], v[136:139], v[244:247], v[80:95]
    s_waitcnt lgkmcnt(8)
    ds_read_b64_tr_b16 v[240:241], v18 offset:12288
    ds_read_b64_tr_b16 v[242:243], v18 offset:12800
    ds_read_b64_tr_b16 v[244:245], v19 offset:12288
    ds_read_b64_tr_b16 v[246:247], v19 offset:12800
    v_mfma_f32_32x32x16_bf16 v[64:79], v[140:143], v[248:251], v[64:79]
    v_mfma_f32_32x32x16_bf16 v[80:95], v[140:143], v[252:255], v[80:95]
    s_waitcnt lgkmcnt(8)
    ds_read_b64_tr_b16 v[248:249], v18 offset:14336
    ds_read_b64_tr_b16 v[250:251], v18 offset:14848
    ds_read_b64_tr_b16 v[252:253], v19 offset:14336
    ds_read_b64_tr_b16 v[254:255], v19 offset:14848
    v_mfma_f32_32x32x16_bf16 v[64:79], v[144:147], v[48:51], v[64:79]
    v_mfma_f32_32x32x16_bf16 v[80:95], v[144:147], v[52:55], v[80:95]
    s_waitcnt lgkmcnt(8)
    ds_read_b64_tr_b16 v[48:49], v18 offset:16384
    ds_read_b64_tr_b16 v[50:51], v18 offset:16896
    ds_read_b64_tr_b16 v[52:53], v19 offset:16384
    ds_read_b64_tr_b16 v[54:55], v19 offset:16896
    v_mfma_f32_32x32x16_bf16 v[64:79], v[148:151], v[56:59], v[64:79]
    v_mfma_f32_32x32x16_bf16 v[80:95], v[148:151], v[60:63], v[80:95]
    s_waitcnt lgkmcnt(8)
    ds_read_b64_tr_b16 v[56:57], v18 offset:18432
    ds_read_b64_tr_b16 v[58:59], v18 offset:18944
    ds_read_b64_tr_b16 v[60:61], v19 offset:18432
    ds_read_b64_tr_b16 v[62:63], v19 offset:18944
    v_mfma_f32_32x32x16_bf16 v[64:79], v[152:155], v[240:243], v[64:79]
    v_mfma_f32_32x32x16_bf16 v[80:95], v[152:155], v[244:247], v[80:95]
    s_waitcnt lgkmcnt(8)
    ds_read_b64_tr_b16 v[240:241], v18 offset:20480
    ds_read_b64_tr_b16 v[242:243], v18 offset:20992
    ds_read_b64_tr_b16 v[244:245], v19 offset:20480
    ds_read_b64_tr_b16 v[246:247], v19 offset:20992
    v_mfma_f32_32x32x16_bf16 v[64:79], v[156:159], v[248:251], v[64:79]
    v_mfma_f32_32x32x16_bf16 v[80:95], v[156:159], v[252:255], v[80:95]
    s_waitcnt lgkmcnt(8)
    ds_read_b64_tr_b16 v[248:249], v18 offset:22528
    ds_read_b64_tr_b16 v[250:251], v18 offset:23040
    ds_read_b64_tr_b16 v[252:253], v19 offset:22528
    ds_read_b64_tr_b16 v[254:255], v19 offset:23040
    v_mfma_f32_32x32x16_bf16 v[64:79], v[160:163], v[48:51], v[64:79]
    v_mfma_f32_32x32x16_bf16 v[80:95], v[160:163], v[52:55], v[80:95]
    s_waitcnt lgkmcnt(8)
    ds_read_b64_tr_b16 v[48:49], v18 offset:24576
    ds_read_b64_tr_b16 v[50:51], v18 offset:25088
    ds_read_b64_tr_b16 v[52:53], v19 offset:24576
    ds_read_b64_tr_b16 v[54:55], v19 offset:25088
    v_mfma_f32_32x32x16_bf16 v[64:79], v[164:167], v[56:59], v[64:79]
    v_mfma_f32_32x32x16_bf16 v[80:95], v[164:167], v[60:63], v[80:95]
    s_waitcnt lgkmcnt(8)
    ds_read_b64_tr_b16 v[56:57], v18 offset:26624
    ds_read_b64_tr_b16 v[58:59], v18 offset:27136
    ds_read_b64_tr_b16 v[60:61], v19 offset:26624
    ds_read_b64_tr_b16 v[62:63], v19 offset:27136
    v_mfma_f32_32x32x16_bf16 v[64:79], v[168:171], v[240:243], v[64:79]
    v_mfma_f32_32x32x16_bf16 v[80:95], v[168:171], v[244:247], v[80:95]
    s_waitcnt lgkmcnt(8)
    ds_read_b64_tr_b16 v[240:241], v18 offset:28672
    ds_read_b64_tr_b16 v[242:243], v18 offset:29184
    ds_read_b64_tr_b16 v[244:245], v19 offset:28672
    ds_read_b64_tr_b16 v[246:247], v19 offset:29184
    v_mfma_f32_32x32x16_bf16 v[64:79], v[172:175], v[248:251], v[64:79]
    v_mfma_f32_32x32x16_bf16 v[80:95], v[172:175], v[252:255], v[80:95]
    s_waitcnt lgkmcnt(8)
    ds_read_b64_tr_b16 v[248:249], v18 offset:30720
    ds_read_b64_tr_b16 v[250:251], v18 offset:31232
    ds_read_b64_tr_b16 v[252:253], v19 offset:30720
    ds_read_b64_tr_b16 v[254:255], v19 offset:31232
    v_mfma_f32_32x32x16_bf16 v[64:79], v[176:179], v[48:51], v[64:79]
    v_mfma_f32_32x32x16_bf16 v[80:95], v[176:179], v[52:55], v[80:95]
    s_waitcnt lgkmcnt(8)
    ds_read_b64_tr_b16 v[48:49], v18 offset:32768
    ds_read_b64_tr_b16 v[50:51], v18 offset:33280
    ds_read_b64_tr_b16 v[52:53], v19 offset:32768
    ds_read_b64_tr_b16 v[54:55], v19 offset:33280
    v_mfma_f32_32x32x16_bf16 v[64:79], v[180:183], v[56:59], v[64:79]
    v_mfma_f32_32x32x16_bf16 v[80:95], v[180:183], v[60:63], v[80:95]
    s_waitcnt lgkmcnt(8)
    ds_read_b64_tr_b16 v[56:57], v18 offset:34816
    ds_read_b64_tr_b16 v[58:59], v18 offset:35328
    ds_read_b64_tr_b16 v[60:61], v19 offset:34816
    ds_read_b64_tr_b16 v[62:63], v19 offset:35328
    v_mfma_f32_32x32x16_bf16 v[64:79], v[184:187], v[240:243], v[64:79]
    v_mfma_f32_32x32x16_bf16 v[80:95], v[184:187], v[244:247], v[80:95]
    s_waitcnt lgkmcnt(8)
    ds_read_b64_tr_b16 v[240:241], v18 offset:36864
    ds_read_b64_tr_b16 v[242:243], v18 offset:37376
    ds_read_b64_tr_b16 v[244:245], v19 offset:36864
    ds_read_b64_tr_b16 v[246:247], v19 offset:37376
    v_mfma_f32_32x32x16_bf16 v[64:79], v[188:191], v[248:251], v[64:79]
    v_mfma_f32_32x32x16_bf16 v[80:95], v[188:191], v[252:255], v[80:95]
    s_waitcnt lgkmcnt(8)
    ds_read_b64_tr_b16 v[248:249], v18 offset:38912
    ds_read_b64_tr_b16 v[250:251], v18 offset:39424
    ds_read_b64_tr_b16 v[252:253], v19 offset:38912
    ds_read_b64_tr_b16 v[254:255], v19 offset:39424
    v_mfma_f32_32x32x16_bf16 v[64:79], v[192:195], v[48:51], v[64:79]
    v_mfma_f32_32x32x16_bf16 v[80:95], v[192:195], v[52:55], v[80:95]
    s_waitcnt lgkmcnt(8)
    ds_read_b64_tr_b16 v[48:49], v18 offset:40960
    ds_read_b64_tr_b16 v[50:51], v18 offset:41472
    ds_read_b64_tr_b16 v[52:53], v19 offset:40960
    ds_read_b64_tr_b16 v[54:55], v19 offset:41472
    v_mfma_f32_32x32x16_bf16 v[64:79], v[196:199], v[56:59], v[64:79]
    v_mfma_f32_32x32x16_bf16 v[80:95], v[196:199], v[60:63], v[80:95]
    s_waitcnt lgkmcnt(8)
    ds_read_b64_tr_b16 v[56:57], v18 offset:43008
    ds_read_b64_tr_b16 v[58:59], v18 offset:43520
    ds_read_b64_tr_b16 v[60:61], v19 offset:43008
    ds_read_b64_tr_b16 v[62:63], v19 offset:43520
    v_mfma_f32_32x32x16_bf16 v[64:79], v[200:203], v[240:243], v[64:79]
    v_mfma_f32_32x32x16_bf16 v[80:95], v[200:203], v[244:247], v[80:95]
    s_waitcnt lgkmcnt(8)
    ds_read_b64_tr_b16 v[240:241], v18 offset:45056
    ds_read_b64_tr_b16 v[242:243], v18 offset:45568
    ds_read_b64_tr_b16 v[244:245], v19 offset:45056
    ds_read_b64_tr_b16 v[246:247], v19 offset:45568
    v_mfma_f32_32x32x16_bf16 v[64:79], v[204:207], v[248:251], v[64:79]
    v_mfma_f32_32x32x16_bf16 v[80:95], v[204:207], v[252:255], v[80:95]
    s_waitcnt lgkmcnt(8)
    ds_read_b64_tr_b16 v[248:249], v18 offset:47104
    ds_read_b64_tr_b16 v[250:251], v18 offset:47616
    ds_read_b64_tr_b16 v[252:253], v19 offset:47104
    ds_read_b64_tr_b16 v[254:255], v19 offset:47616
    v_mfma_f32_32x32x16_bf16 v[64:79], v[208:211], v[48:51], v[64:79]
    v_mfma_f32_32x32x16_bf16 v[80:95], v[208:211], v[52:55], v[80:95]
    ds_read_b32 v29, v27 offset:12
    s_waitcnt lgkmcnt(9)
    ds_read_b64_tr_b16 v[48:49], v18 offset:49152
    ds_read_b64_tr_b16 v[50:51], v18 offset:49664
    ds_read_b64_tr_b16 v[52:53], v19 offset:49152
    ds_read_b64_tr_b16 v[54:55], v19 offset:49664
    v_mfma_f32_32x32x16_bf16 v[64:79], v[212:215], v[56:59], v[64:79]
    v_mfma_f32_32x32x16_bf16 v[80:95], v[212:215], v[60:63], v[80:95]
    ds_read_b128 v[32:35], v12 offset:0
    ds_read_b128 v[36:39], v12 offset:32
    s_waitcnt lgkmcnt(12)
    ds_read_b128 v[40:43], v12 offset:64
    ds_read_b128 v[44:47], v12 offset:96
    s_waitcnt lgkmcnt(13)
    ds_read_b64_tr_b16 v[56:57], v18 offset:51200
    ds_read_b64_tr_b16 v[58:59], v18 offset:51712
    s_waitcnt lgkmcnt(12)
    ds_read_b64_tr_b16 v[60:61], v19 offset:51200
    ds_read_b64_tr_b16 v[62:63], v19 offset:51712
    v_mfma_f32_32x32x16_bf16 v[64:79], v[216:219], v[240:243], v[64:79]
    v_mfma_f32_32x32x16_bf16 v[80:95], v[216:219], v[244:247], v[80:95]
    s_waitcnt lgkmcnt(13)
    ds_read_b64_tr_b16 v[240:241], v18 offset:53248
    ds_read_b64_tr_b16 v[242:243], v18 offset:53760
    s_waitcnt lgkmcnt(12)
    ds_read_b64_tr_b16 v[244:245], v19 offset:53248
    ds_read_b64_tr_b16 v[246:247], v19 offset:53760
    v_mfma_f32_32x32x16_bf16 v[64:79], v[220:223], v[248:251], v[64:79]
    v_mfma_f32_32x32x16_bf16 v[80:95], v[220:223], v[252:255], v[80:95]
    s_waitcnt lgkmcnt(12)
    ds_read_b64_tr_b16 v[248:249], v18 offset:55296
    ds_read_b64_tr_b16 v[250:251], v18 offset:55808
    ds_read_b64_tr_b16 v[252:253], v19 offset:55296
    s_waitcnt lgkmcnt(12)
    ds_read_b64_tr_b16 v[254:255], v19 offset:55808
    v_mfma_f32_32x32x16_bf16 v[64:79], v[224:227], v[48:51], v[64:79]
    v_mfma_f32_32x32x16_bf16 v[80:95], v[224:227], v[52:55], v[80:95]
    s_waitcnt lgkmcnt(14)
    v_readfirstlane_b32 s97, v29
    s_nop 0
    s_cmp_lt_u32 s97, 4
    s_cbranch_scc1 AC_6
AC_6_r:
    s_waitcnt lgkmcnt(8)
    ds_read_b64_tr_b16 v[48:49], v20 offset:0
    ds_read_b64_tr_b16 v[50:51], v20 offset:256
    ds_read_b64_tr_b16 v[52:53], v20 offset:1024
    ds_read_b64_tr_b16 v[54:55], v20 offset:1280
    v_mfma_f32_32x32x16_bf16 v[64:79], v[228:231], v[56:59], v[64:79]
    v_mfma_f32_32x32x16_bf16 v[80:95], v[228:231], v[60:63], v[80:95]
    s_waitcnt lgkmcnt(8)
    ds_read_b64_tr_b16 v[56:57], v20 offset:2048
    ds_read_b64_tr_b16 v[58:59], v20 offset:2304
    ds_read_b64_tr_b16 v[60:61], v20 offset:3072
    ds_read_b64_tr_b16 v[62:63], v20 offset:3328
    v_mfma_f32_32x32x16_bf16 v[64:79], v[232:235], v[240:243], v[64:79]
    v_mfma_f32_32x32x16_bf16 v[80:95], v[232:235], v[244:247], v[80:95]
    s_waitcnt lgkmcnt(8)
    ds_read_b64_tr_b16 v[240:241], v20 offset:4096
    ds_read_b64_tr_b16 v[242:243], v20 offset:4352
    ds_read_b64_tr_b16 v[244:245], v20 offset:5120
    ds_read_b64_tr_b16 v[246:247], v20 offset:5376
    s_mov_b64 exec, 1
    ds_add_u32 v27, v30 offset:28
    s_mov_b64 exec, -1
    v_mfma_f32_32x32x16_bf16 v[64:79], v[236:239], v[248:251], v[64:79]
    v_mfma_f32_32x32x16_bf16 v[80:95], v[236:239], v[252:255], v[80:95]
    s_waitcnt lgkmcnt(14)
    s_waitcnt lgkmcnt(9)
    ds_read_b64_tr_b16 v[248:249], v20 offset:6144
    ds_read_b64_tr_b16 v[250:251], v20 offset:6400
    ds_read_b64_tr_b16 v[252:253], v20 offset:7168
    ds_read_b64_tr_b16 v[254:255], v20 offset:7424
    v_mfma_f32_32x32x16_bf16 v[96:111], v[48:51], v[128:131], 0
    v_mfma_f32_32x32x16_bf16 v[96:111], v[52:55], v[132:135], v[96:111]
    s_waitcnt lgkmcnt(9)
    ds_read_b64_tr_b16 v[48:49], v20 offset:8192
    ds_read_b64_tr_b16 v[50:51], v20 offset:8448
    ds_read_b64_tr_b16 v[52:53], v20 offset:9216
    ds_read_b64_tr_b16 v[54:55], v20 offset:9472
    v_mfma_f32_32x32x16_bf16 v[96:111], v[56:59], v[136:139], v[96:111]
    v_mfma_f32_32x32x16_bf16 v[96:111], v[60:63], v[140:143], v[96:111]
    v_mul_f32 v64, v64, v32
    v_mul_f32 v65, v65, v33
    s_waitcnt lgkmcnt(9)
    ds_read_b64_tr_b16 v[56:57], v20 offset:10240
    ds_read_b64_tr_b16 v[58:59], v20 offset:10496
    ds_read_b64_tr_b16 v[60:61], v20 offset:11264
    ds_read_b64_tr_b16 v[62:63], v20 offset:11520
    v_mfma_f32_32x32x16_bf16 v[96:111], v[240:243], v[144:147], v[96:111]
    v_mul_f32 v66, v66, v34
    v_mul_f32 v67, v67, v35
    v_mfma_f32_32x32x16_bf16 v[96:111], v[244:247], v[148:151], v[96:111]
    v_mul_f32 v68, v68, v36
    v_mul_f32 v69, v69, v37
    s_waitcnt lgkmcnt(8)
    ds_read_b64_tr_b16 v[240:241], v20 offset:12288
    ds_read_b64_tr_b16 v[242:243], v20 offset:12544
    ds_read_b64_tr_b16 v[244:245], v20 offset:13312
    ds_read_b64_tr_b16 v[246:247], v20 offset:13568
    v_mfma_f32_32x32x16_bf16 v[96:111], v[248:251], v[152:155], v[96:111]
    v_mul_f32 v70, v70, v38
    v_mul_f32 v71, v71, v39
    v_cvt_pk_bf16_f32 v64, v64, v65
    v_mfma_f32_32x32x16_bf16 v[96:111], v[252:255], v[156:159], v[96:111]
    v_cvt_pk_bf16_f32 v65, v66, v67
    v_cvt_pk_bf16_f32 v66, v68, v69
    s_waitcnt lgkmcnt(8)
    ds_read_b64_tr_b16 v[248:249], v20 offset:14336
    ds_read_b64_tr_b16 v[250:251], v20 offset:14592
    ds_read_b64_tr_b16 v[252:253], v20 offset:15360
    ds_read_b64_tr_b16 v[254:255], v20 offset:15616
    v_mfma_f32_32x32x16_bf16 v[96:111], v[48:51], v[160:163], v[96:111]
    v_cvt_pk_bf16_f32 v67, v70, v71
    buffer_store_dwordx4 v[64:67], v23, s[24:27], s71 offen offset:0 sc1
    v_mfma_f32_32x32x16_bf16 v[96:111], v[52:55], v[164:167], v[96:111]
    v_mul_f32 v72, v72, v40
    v_mul_f32 v73, v73, v41
    s_waitcnt lgkmcnt(8)
    ds_read_b64_tr_b16 v[48:49], v20 offset:16384
    ds_read_b64_tr_b16 v[50:51], v20 offset:16640
    ds_read_b64_tr_b16 v[52:53], v20 offset:17408
    ds_read_b64_tr_b16 v[54:55], v20 offset:17664
    v_mfma_f32_32x32x16_bf16 v[96:111], v[56:59], v[168:171], v[96:111]
    v_mul_f32 v74, v74, v42
    v_mul_f32 v75, v75, v43
    v_mul_f32 v76, v76, v44
    v_mfma_f32_32x32x16_bf16 v[96:111], v[60:63], v[172:175], v[96:111]
    v_mul_f32 v77, v77, v45
    v_mul_f32 v78, v78, v46
    s_waitcnt lgkmcnt(8)
    ds_read_b64_tr_b16 v[56:57], v20 offset:18432
    ds_read_b64_tr_b16 v[58:59], v20 offset:18688
    ds_read_b64_tr_b16 v[60:61], v20 offset:19456
    ds_read_b64_tr_b16 v[62:63], v20 offset:19712
    v_mfma_f32_32x32x16_bf16 v[96:111], v[240:243], v[176:179], v[96:111]
    v_mul_f32 v79, v79, v47
    v_cvt_pk_bf16_f32 v72, v72, v73
    v_mfma_f32_32x32x16_bf16 v[96:111], v[244:247], v[180:183], v[96:111]
    v_cvt_pk_bf16_f32 v73, v74, v75
    v_cvt_pk_bf16_f32 v74, v76, v77
    ds_read_b32 v29, v27 offset:16
    s_waitcnt lgkmcnt(9)
    ds_read_b64_tr_b16 v[240:241], v20 offset:20480
    ds_read_b64_tr_b16 v[242:243], v20 offset:20736
    ds_read_b64_tr_b16 v[244:245], v20 offset:21504
    ds_read_b64_tr_b16 v[246:247], v20 offset:21760
    v_mfma_f32_32x32x16_bf16 v[96:111], v[248:251], v[184:187], v[96:111]
    v_cvt_pk_bf16_f32 v75, v78, v79
    buffer_store_dwordx4 v[72:75], v23, s[24:27], s72 offen offset:0 sc1
    v_mul_f32 v80, v80, v32
    v_mfma_f32_32x32x16_bf16 v[96:111], v[252:255], v[188:191], v[96:111]
    v_mul_f32 v81, v81, v33
    v_mul_f32 v82, v82, v34
    s_waitcnt lgkmcnt(9)
    ds_read_b64_tr_b16 v[248:249], v20 offset:22528
    ds_read_b64_tr_b16 v[250:251], v20 offset:22784
    ds_read_b64_tr_b16 v[252:253], v20 offset:23552
    ds_read_b64_tr_b16 v[254:255], v20 offset:23808
    v_mfma_f32_32x32x16_bf16 v[96:111], v[48:51], v[192:195], v[96:111]
    v_mul_f32 v83, v83, v35
    v_mul_f32 v84, v84, v36
    v_mfma_f32_32x32x16_bf16 v[96:111], v[52:55], v[196:199], v[96:111]
    v_mul_f32 v85, v85, v37
    v_mul_f32 v86, v86, v38
    s_waitcnt lgkmcnt(9)
    ds_read_b64_tr_b16 v[48:49], v20 offset:24576
    ds_read_b64_tr_b16 v[50:51], v20 offset:24832
    ds_read_b64_tr_b16 v[52:53], v20 offset:25600
    ds_read_b64_tr_b16 v[54:55], v20 offset:25856
    v_mfma_f32_32x32x16_bf16 v[96:111], v[56:59], v[200:203], v[96:111]
    v_mul_f32 v87, v87, v39
    v_cvt_pk_bf16_f32 v80, v80, v81
    v_cvt_pk_bf16_f32 v81, v82, v83
    v_mfma_f32_32x32x16_bf16 v[96:111], v[60:63], v[204:207], v[96:111]
    v_cvt_pk_bf16_f32 v82, v84, v85
    v_cvt_pk_bf16_f32 v83, v86, v87
    s_waitcnt lgkmcnt(8)
    ds_read_b64_tr_b16 v[56:57], v20 offset:26624
    ds_read_b64_tr_b16 v[58:59], v20 offset:26880
    ds_read_b64_tr_b16 v[60:61], v20 offset:27648
    ds_read_b64_tr_b16 v[62:63], v20 offset:27904
    v_mfma_f32_32x32x16_bf16 v[96:111], v[240:243], v[208:211], v[96:111]
    buffer_store_dwordx4 v[80:83], v23, s[24:27], s71 offen offset:512 sc1
    v_mul_f32 v88, v88, v40
    v_mfma_f32_32x32x16_bf16 v[96:111], v[244:247], v[212:215], v[96:111]
    v_mul_f32 v89, v89, v41
    v_mul_f32 v90, v90, v42
    s_waitcnt lgkmcnt(14)
    v_readfirstlane_b32 s97, v29
    s_nop 0
    s_cmp_lt_u32 s97, 4
    s_cbranch_scc1 AC_7
AC_7_r:
    s_waitcnt lgkmcnt(8)
    ds_read_b64_tr_b16 v[240:241], v16 offset:0
    ds_read_b64_tr_b16 v[242:243], v16 offset:512
    ds_read_b64_tr_b16 v[244:245], v17 offset:0
    ds_read_b64_tr_b16 v[246:247], v17 offset:512
    v_mfma_f32_32x32x16_bf16 v[96:111], v[248:251], v[216:219], v[96:111]
    v_mul_f32 v91, v91, v43
    v_mul_f32 v92, v92, v44
    v_mul_f32 v93, v93, v45
    v_mfma_f32_32x32x16_bf16 v[96:111], v[252:255], v[220:223], v[96:111]
    v_mul_f32 v94, v94, v46
    v_mul_f32 v95, v95, v47
    s_waitcnt lgkmcnt(8)
    ds_read_b64_tr_b16 v[248:249], v16 offset:2048
    ds_read_b64_tr_b16 v[250:251], v16 offset:2560
    ds_read_b64_tr_b16 v[252:253], v17 offset:2048
    ds_read_b64_tr_b16 v[254:255], v17 offset:2560
    v_mfma_f32_32x32x16_bf16 v[96:111], v[48:51], v[224:227], v[96:111]
    v_cvt_pk_bf16_f32 v88, v88, v89
    v_cvt_pk_bf16_f32 v89, v90, v91
    v_mfma_f32_32x32x16_bf16 v[96:111], v[52:55], v[228:231], v[96:111]
    v_cvt_pk_bf16_f32 v90, v92, v93
    v_cvt_pk_bf16_f32 v91, v94, v95
    buffer_store_dwordx4 v[88:91], v23, s[24:27], s72 offen offset:512 sc1
    s_waitcnt lgkmcnt(8)
    ds_read_b64_tr_b16 v[48:49], v16 offset:4096
    ds_read_b64_tr_b16 v[50:51], v16 offset:4608
    ds_read_b64_tr_b16 v[52:53], v17 offset:4096
    ds_read_b64_tr_b16 v[54:55], v17 offset:4608
    s_mov_b64 exec, 1
    ds_add_u32 v27, v30 offset:32
    s_mov_b64 exec, -1
    v_mfma_f32_32x32x16_bf16 v[96:111], v[56:59], v[232:235], v[96:111]
    v_mfma_f32_32x32x16_bf16 v[96:111], v[60:63], v[236:239], v[96:111]
    s_waitcnt lgkmcnt(9)
    ds_read_b64_tr_b16 v[56:57], v16 offset:6144
    ds_read_b64_tr_b16 v[58:59], v16 offset:6656
    ds_read_b64_tr_b16 v[60:61], v17 offset:6144
    ds_read_b64_tr_b16 v[62:63], v17 offset:6656
    v_mfma_f32_32x32x16_bf16 v[64:79], v[240:243], v[128:131], 0
    v_mfma_f32_32x32x16_bf16 v[80:95], v[244:247], v[128:131], 0
    s_waitcnt lgkmcnt(9)
    ds_read_b64_tr_b16 v[240:241], v16 offset:8192
    ds_read_b64_tr_b16 v[242:243], v16 offset:8704
    ds_read_b64_tr_b16 v[244:245], v17 offset:8192
    ds_read_b64_tr_b16 v[246:247], v17 offset:8704
    v_mfma_f32_32x32x16_bf16 v[64:79], v[248:251], v[132:135], v[64:79]
    v_mfma_f32_32x32x16_bf16 v[80:95], v[252:255], v[132:135], v[80:95]
    v_mul_f32 v96, v96, v2
    v_mul_f32 v97, v97, v2
    v_mul_f32 v98, v98, v2
    v_mul_f32 v99, v99, v2
    s_waitcnt lgkmcnt(9)
    ds_read_b64_tr_b16 v[248:249], v16 offset:10240
    ds_read_b64_tr_b16 v[250:251], v16 offset:10752
    ds_read_b64_tr_b16 v[252:253], v17 offset:10240
    ds_read_b64_tr_b16 v[254:255], v17 offset:10752
    v_mfma_f32_32x32x16_bf16 v[64:79], v[48:51], v[136:139], v[64:79]
    v_cvt_pk_bf16_f32 v96, v96, v97
    v_cvt_pk_bf16_f32 v97, v98, v99
    buffer_store_dwordx2 v[96:97], v21, s[24:27], s67 offen offset:0 sc1
    v_mul_f32 v100, v100, v2
    v_mfma_f32_32x32x16_bf16 v[80:95], v[52:55], v[136:139], v[80:95]
    v_mul_f32 v101, v101, v2
    v_mul_f32 v102, v102, v2
    v_mul_f32 v103, v103, v2
    v_cvt_pk_bf16_f32 v100, v100, v101
    s_waitcnt lgkmcnt(8)
    ds_read_b64_tr_b16 v[48:49], v16 offset:12288
    ds_read_b64_tr_b16 v[50:51], v16 offset:12800
    ds_read_b64_tr_b16 v[52:53], v17 offset:12288
    ds_read_b64_tr_b16 v[54:55], v17 offset:12800
    v_mfma_f32_32x32x16_bf16 v[64:79], v[56:59], v[140:143], v[64:79]
    v_cvt_pk_bf16_f32 v101, v102, v103
    buffer_store_dwordx2 v[100:101], v21, s[24:27], s67 offen offset:512 sc1
    v_mul_f32 v104, v104, v2
    v_mul_f32 v105, v105, v2
    v_mfma_f32_32x32x16_bf16 v[80:95], v[60:63], v[140:143], v[80:95]
    v_mul_f32 v106, v106, v2
    v_mul_f32 v107, v107, v2
    v_cvt_pk_bf16_f32 v104, v104, v105
    v_cvt_pk_bf16_f32 v105, v106, v107
    s_waitcnt lgkmcnt(8)
    ds_read_b64_tr_b16 v[56:57], v16 offset:14336
    ds_read_b64_tr_b16 v[58:59], v16 offset:14848
    ds_read_b64_tr_b16 v[60:61], v17 offset:14336
    ds_read_b64_tr_b16 v[62:63], v17 offset:14848
    v_mfma_f32_32x32x16_bf16 v[64:79], v[240:243], v[144:147], v[64:79]
    buffer_store_dwordx2 v[104:105], v21, s[24:27], s67 offen offset:1024 sc1
    v_mul_f32 v108, v108, v2
    v_mul_f32 v109, v109, v2
    v_mul_f32 v110, v110, v2
    v_mfma_f32_32x32x16_bf16 v[80:95], v[244:247], v[144:147], v[80:95]
    v_mul_f32 v111, v111, v2
    v_cvt_pk_bf16_f32 v108, v108, v109
    v_cvt_pk_bf16_f32 v109, v110, v111
    buffer_store_dwordx2 v[108:109], v21, s[24:27], s67 offen offset:1536 sc1
    s_waitcnt lgkmcnt(8)
    ds_read_b64_tr_b16 v[240:241], v16 offset:16384
    ds_read_b64_tr_b16 v[242:243], v16 offset:16896
    ds_read_b64_tr_b16 v[244:245], v17 offset:16384
    ds_read_b64_tr_b16 v[246:247], v17 offset:16896
    v_mfma_f32_32x32x16_bf16 v[64:79], v[248:251], v[148:151], v[64:79]
    v_mfma_f32_32x32x16_bf16 v[80:95], v[252:255], v[148:151], v[80:95]
    s_waitcnt lgkmcnt(8)
    ds_read_b64_tr_b16 v[248:249], v16 offset:18432
    ds_read_b64_tr_b16 v[250:251], v16 offset:18944
    ds_read_b64_tr_b16 v[252:253], v17 offset:18432
    ds_read_b64_tr_b16 v[254:255], v17 offset:18944
    v_mfma_f32_32x32x16_bf16 v[64:79], v[48:51], v[152:155], v[64:79]
    v_mfma_f32_32x32x16_bf16 v[80:95], v[52:55], v[152:155], v[80:95]
    s_waitcnt lgkmcnt(8)
    ds_read_b64_tr_b16 v[48:49], v16 offset:20480
    ds_read_b64_tr_b16 v[50:51], v16 offset:20992
    ds_read_b64_tr_b16 v[52:53], v17 offset:20480
    ds_read_b64_tr_b16 v[54:55], v17 offset:20992
    v_mfma_f32_32x32x16_bf16 v[64:79], v[56:59], v[156:159], v[64:79]
    v_mfma_f32_32x32x16_bf16 v[80:95], v[60:63], v[156:159], v[80:95]
    s_waitcnt lgkmcnt(8)
    ds_read_b64_tr_b16 v[56:57], v16 offset:22528
    ds_read_b64_tr_b16 v[58:59], v16 offset:23040
    ds_read_b64_tr_b16 v[60:61], v17 offset:22528
    ds_read_b64_tr_b16 v[62:63], v17 offset:23040
    v_mfma_f32_32x32x16_bf16 v[64:79], v[240:243], v[160:163], v[64:79]
    v_mfma_f32_32x32x16_bf16 v[80:95], v[244:247], v[160:163], v[80:95]
    s_waitcnt lgkmcnt(8)
    ds_read_b64_tr_b16 v[240:241], v16 offset:24576
    ds_read_b64_tr_b16 v[242:243], v16 offset:25088
    ds_read_b64_tr_b16 v[244:245], v17 offset:24576
    ds_read_b64_tr_b16 v[246:247], v17 offset:25088
    v_mfma_f32_32x32x16_bf16 v[64:79], v[248:251], v[164:167], v[64:79]
    v_mfma_f32_32x32x16_bf16 v[80:95], v[252:255], v[164:167], v[80:95]
    s_waitcnt lgkmcnt(8)
    ds_read_b64_tr_b16 v[248:249], v16 offset:26624
    ds_read_b64_tr_b16 v[250:251], v16 offset:27136
    ds_read_b64_tr_b16 v[252:253], v17 offset:26624
    ds_read_b64_tr_b16 v[254:255], v17 offset:27136
    v_mfma_f32_32x32x16_bf16 v[64:79], v[48:51], v[168:171], v[64:79]
    v_mfma_f32_32x32x16_bf16 v[80:95], v[52:55], v[168:171], v[80:95]
    s_waitcnt lgkmcnt(8)
    ds_read_b64_tr_b16 v[48:49], v16 offset:28672
    ds_read_b64_tr_b16 v[50:51], v16 offset:29184
    ds_read_b64_tr_b16 v[52:53], v17 offset:28672
    ds_read_b64_tr_b16 v[54:55], v17 offset:29184
    v_mfma_f32_32x32x16_bf16 v[64:79], v[56:59], v[172:175], v[64:79]
    v_mfma_f32_32x32x16_bf16 v[80:95], v[60:63], v[172:175], v[80:95]
    s_waitcnt lgkmcnt(8)
    ds_read_b64_tr_b16 v[56:57], v16 offset:30720
    ds_read_b64_tr_b16 v[58:59], v16 offset:31232
    ds_read_b64_tr_b16 v[60:61], v17 offset:30720
    ds_read_b64_tr_b16 v[62:63], v17 offset:31232
    v_mfma_f32_32x32x16_bf16 v[64:79], v[240:243], v[176:179], v[64:79]
    v_mfma_f32_32x32x16_bf16 v[80:95], v[244:247], v[176:179], v[80:95]
    s_waitcnt lgkmcnt(8)
    ds_read_b64_tr_b16 v[240:241], v16 offset:32768
    ds_read_b64_tr_b16 v[242:243], v16 offset:33280
    ds_read_b64_tr_b16 v[244:245], v17 offset:32768
    ds_read_b64_tr_b16 v[246:247], v17 offset:33280
    v_mfma_f32_32x32x16_bf16 v[64:79], v[248:251], v[180:183], v[64:79]
    v_mfma_f32_32x32x16_bf16 v[80:95], v[252:255], v[180:183], v[80:95]
    s_waitcnt lgkmcnt(8)
    ds_read_b64_tr_b16 v[248:249], v16 offset:34816
    ds_read_b64_tr_b16 v[250:251], v16 offset:35328
    ds_read_b64_tr_b16 v[252:253], v17 offset:34816
    ds_read_b64_tr_b16 v[254:255], v17 offset:35328
    v_mfma_f32_32x32x16_bf16 v[64:79], v[48:51], v[184:187], v[64:79]
    v_mfma_f32_32x32x16_bf16 v[80:95], v[52:55], v[184:187], v[80:95]
    s_waitcnt lgkmcnt(8)
    ds_read_b64_tr_b16 v[48:49], v16 offset:36864
    ds_read_b64_tr_b16 v[50:51], v16 offset:37376
    ds_read_b64_tr_b16 v[52:53], v17 offset:36864
    ds_read_b64_tr_b16 v[54:55], v17 offset:37376
    v_mfma_f32_32x32x16_bf16 v[64:79], v[56:59], v[188:191], v[64:79]
    v_mfma_f32_32x32x16_bf16 v[80:95], v[60:63], v[188:191], v[80:95]
    s_waitcnt lgkmcnt(8)
    ds_read_b64_tr_b16 v[56:57], v16 offset:38912
    ds_read_b64_tr_b16 v[58:59], v16 offset:39424
    ds_read_b64_tr_b16 v[60:61], v17 offset:38912
    ds_read_b64_tr_b16 v[62:63], v17 offset:39424
    v_mfma_f32_32x32x16_bf16 v[64:79], v[240:243], v[192:195], v[64:79]
    v_mfma_f32_32x32x16_bf16 v[80:95], v[244:247], v[192:195], v[80:95]
    s_waitcnt lgkmcnt(8)
    ds_read_b64_tr_b16 v[240:241], v16 offset:40960
    ds_read_b64_tr_b16 v[242:243], v16 offset:41472
    ds_read_b64_tr_b16 v[244:245], v17 offset:40960
    ds_read_b64_tr_b16 v[246:247], v17 offset:41472
    v_mfma_f32_32x32x16_bf16 v[64:79], v[248:251], v[196:199], v[64:79]
    v_mfma_f32_32x32x16_bf16 v[80:95], v[252:255], v[196:199], v[80:95]
    s_waitcnt lgkmcnt(8)
    ds_read_b64_tr_b16 v[248:249], v16 offset:43008
    ds_read_b64_tr_b16 v[250:251], v16 offset:43520
    ds_read_b64_tr_b16 v[252:253], v17 offset:43008
    ds_read_b64_tr_b16 v[254:255], v17 offset:43520
    v_mfma_f32_32x32x16_bf16 v[64:79], v[48:51], v[200:203], v[64:79]
    v_mfma_f32_32x32x16_bf16 v[80:95], v[52:55], v[200:203], v[80:95]
    s_waitcnt lgkmcnt(8)
    ds_read_b64_tr_b16 v[48:49], v16 offset:45056
    ds_read_b64_tr_b16 v[50:51], v16 offset:45568
    ds_read_b64_tr_b16 v[52:53], v17 offset:45056
    ds_read_b64_tr_b16 v[54:55], v17 offset:45568
    v_mfma_f32_32x32x16_bf16 v[64:79], v[56:59], v[204:207], v[64:79]
    v_mfma_f32_32x32x16_bf16 v[80:95], v[60:63], v[204:207], v[80:95]
    s_waitcnt lgkmcnt(8)
    ds_read_b64_tr_b16 v[56:57], v16 offset:47104
    ds_read_b64_tr_b16 v[58:59], v16 offset:47616
    ds_read_b64_tr_b16 v[60:61], v17 offset:47104
    ds_read_b64_tr_b16 v[62:63], v17 offset:47616
    v_mfma_f32_32x32x16_bf16 v[64:79], v[240:243], v[208:211], v[64:79]
    v_mfma_f32_32x32x16_bf16 v[80:95], v[244:247], v[208:211], v[80:95]
    ds_read_b32 v29, v27 offset:20
    s_waitcnt lgkmcnt(9)
    ds_read_b64_tr_b16 v[240:241], v16 offset:49152
    ds_read_b64_tr_b16 v[242:243], v16 offset:49664
    ds_read_b64_tr_b16 v[244:245], v17 offset:49152
    ds_read_b64_tr_b16 v[246:247], v17 offset:49664
    v_mfma_f32_32x32x16_bf16 v[64:79], v[248:251], v[212:215], v[64:79]
    v_mfma_f32_32x32x16_bf16 v[80:95], v[252:255], v[212:215], v[80:95]
    s_waitcnt lgkmcnt(9)
    ds_read_b64_tr_b16 v[248:249], v16 offset:51200
    ds_read_b64_tr_b16 v[250:251], v16 offset:51712
    ds_read_b64_tr_b16 v[252:253], v17 offset:51200
    ds_read_b64_tr_b16 v[254:255], v17 offset:51712
    v_mfma_f32_32x32x16_bf16 v[64:79], v[48:51], v[216:219], v[64:79]
    v_mfma_f32_32x32x16_bf16 v[80:95], v[52:55], v[216:219], v[80:95]
    s_waitcnt lgkmcnt(9)
    ds_read_b64_tr_b16 v[48:49], v16 offset:53248
    ds_read_b64_tr_b16 v[50:51], v16 offset:53760
    ds_read_b64_tr_b16 v[52:53], v17 offset:53248
    ds_read_b64_tr_b16 v[54:55], v17 offset:53760
    v_mfma_f32_32x32x16_bf16 v[64:79], v[56:59], v[220:223], v[64:79]
    v_mfma_f32_32x32x16_bf16 v[80:95], v[60:63], v[220:223], v[80:95]
    s_waitcnt lgkmcnt(8)
    ds_read_b64_tr_b16 v[56:57], v16 offset:55296
    ds_read_b64_tr_b16 v[58:59], v16 offset:55808
    ds_read_b64_tr_b16 v[60:61], v17 offset:55296
    ds_read_b64_tr_b16 v[62:63], v17 offset:55808
    v_mfma_f32_32x32x16_bf16 v[64:79], v[240:243], v[224:227], v[64:79]
    v_mfma_f32_32x32x16_bf16 v[80:95], v[244:247], v[224:227], v[80:95]
    s_waitcnt lgkmcnt(14)
    v_readfirstlane_b32 s97, v29
    s_nop 0
    s_cmp_lt_u32 s97, 4
    s_cbranch_scc1 AC_9
AC_9_r:
    s_waitcnt lgkmcnt(8)
    ds_read_b64_tr_b16 v[240:241], v18 offset:0
    ds_read_b64_tr_b16 v[242:243], v18 offset:512
    ds_read_b64_tr_b16 v[244:245], v19 offset:0
    ds_read_b64_tr_b16 v[246:247], v19 offset:512
    v_mfma_f32_32x32x16_bf16 v[64:79], v[248:251], v[228:231], v[64:79]
    s_waitcnt vmcnt(0)
    s_mov_b64 exec, 1
    ds_add_rtn_u32 v4, v27, v30 offset:48
    s_mov_b64 exec, -1
    v_mfma_f32_32x32x16_bf16 v[80:95], v[252:255], v[228:231], v[80:95]
    s_waitcnt lgkmcnt(9)
    ds_read_b64_tr_b16 v[248:249], v18 offset:2048
    ds_read_b64_tr_b16 v[250:251], v18 offset:2560
    ds_read_b64_tr_b16 v[252:253], v19 offset:2048
    ds_read_b64_tr_b16 v[254:255], v19 offset:2560
    v_mfma_f32_32x32x16_bf16 v[64:79], v[48:51], v[232:235], v[64:79]
    v_mfma_f32_32x32x16_bf16 v[80:95], v[52:55], v[232:235], v[80:95]
    s_waitcnt lgkmcnt(9)
    ds_read_b64_tr_b16 v[48:49], v18 offset:4096
    ds_read_b64_tr_b16 v[50:51], v18 offset:4608
    ds_read_b64_tr_b16 v[52:53], v19 offset:4096
    ds_read_b64_tr_b16 v[54:55], v19 offset:4608
    s_mov_b64 exec, 1
    ds_add_u32 v27, v30 offset:36
    s_mov_b64 exec, -1
    v_mfma_f32_32x32x16_bf16 v[64:79], v[56:59], v[236:239], v[64:79]
    s_waitcnt lgkmcnt(9)
    v_readfirstlane_b32 s97, v4
    s_nop 0
    s_cmp_lg_u32 s97, 3
    s_cbranch_scc1 FG_8
    s_mov_b64 exec, 1
    buffer_store_dword v6, v5, s[24:27], s75 offen sc1
    s_mov_b64 exec, -1
FG_8:
    v_mfma_f32_32x32x16_bf16 v[80:95], v[60:63], v[236:239], v[80:95]
    s_branch A_join
A_pc:
    ds_read_b64_tr_b16 v[48:49], v18 offset:0
    ds_read_b64_tr_b16 v[50:51], v18 offset:512
    ds_read_b64_tr_b16 v[52:53], v19 offset:0
    ds_read_b64_tr_b16 v[54:55], v19 offset:512
    ds_read_b64_tr_b16 v[56:57], v18 offset:2048
    ds_read_b64_tr_b16 v[58:59], v18 offset:2560
    ds_read_b64_tr_b16 v[60:61], v19 offset:2048
    ds_read_b64_tr_b16 v[62:63], v19 offset:2560
    ds_read_b64_tr_b16 v[240:241], v18 offset:4096
    ds_read_b64_tr_b16 v[242:243], v18 offset:4608
    ds_read_b64_tr_b16 v[244:245], v19 offset:4096
    ds_read_b64_tr_b16 v[246:247], v19 offset:4608
    s_waitcnt lgkmcnt(8)
    ds_read_b64_tr_b16 v[248:249], v18 offset:6144
    ds_read_b64_tr_b16 v[250:251], v18 offset:6656
    ds_read_b64_tr_b16 v[252:253], v19 offset:6144
    ds_read_b64_tr_b16 v[254:255], v19 offset:6656
    v_mfma_f32_32x32x16_bf16 v[64:79], v[128:131], v[48:51], 0
    v_mfma_f32_32x32x16_bf16 v[80:95], v[128:131], v[52:55], 0
    s_waitcnt lgkmcnt(8)
    ds_read_b64_tr_b16 v[48:49], v18 offset:8192
    ds_read_b64_tr_b16 v[50:51], v18 offset:8704
    ds_read_b64_tr_b16 v[52:53], v19 offset:8192
    ds_read_b64_tr_b16 v[54:55], v19 offset:8704
    v_mfma_f32_32x32x16_bf16 v[64:79], v[132:135], v[56:59], v[64:79]
    v_mfma_f32_32x32x16_bf16 v[80:95], v[132:135], v[60:63], v[80:95]
    s_waitcnt lgkmcnt(8)
    ds_read_b64_tr_b16 v[56:57], v18 offset:10240
    ds_read_b64_tr_b16 v[58:59], v18 offset:10752
    ds_read_b64_tr_b16 v[60:61], v19 offset:10240
    ds_read_b64_tr_b16 v[62:63], v19 offset:10752
    v_mfma_f32_32x32x16_bf16 v[64:79], v[136:139], v[240:243], v[64:79]
    v_mfma_f32_32x32x16_bf16 v[80:95], v[136:139], v[244:247], v[80:95]
    s_waitcnt lgkmcnt(8)
    ds_read_b64_tr_b16 v[240:241], v18 offset:12288
    ds_read_b64_tr_b16 v[242:243], v18 offset:12800
    ds_read_b64_tr_b16 v[244:245], v19 offset:12288
    ds_read_b64_tr_b16 v[246:247], v19 offset:12800
    v_mfma_f32_32x32x16_bf16 v[64:79], v[140:143], v[248:251], v[64:79]
    v_mfma_f32_32x32x16_bf16 v[80:95], v[140:143], v[252:255], v[80:95]
    s_waitcnt lgkmcnt(8)
    ds_read_b64_tr_b16 v[248:249], v18 offset:14336
    ds_read_b64_tr_b16 v[250:251], v18 offset:14848
    ds_read_b64_tr_b16 v[252:253], v19 offset:14336
    ds_read_b64_tr_b16 v[254:255], v19 offset:14848
    v_mfma_f32_32x32x16_bf16 v[64:79], v[144:147], v[48:51], v[64:79]
    v_mfma_f32_32x32x16_bf16 v[80:95], v[144:147], v[52:55], v[80:95]
    s_waitcnt lgkmcnt(8)
    ds_read_b64_tr_b16 v[48:49], v18 offset:16384
    ds_read_b64_tr_b16 v[50:51], v18 offset:16896
    ds_read_b64_tr_b16 v[52:53], v19 offset:16384
    ds_read_b64_tr_b16 v[54:55], v19 offset:16896
    v_mfma_f32_32x32x16_bf16 v[64:79], v[148:151], v[56:59], v[64:79]
    v_mfma_f32_32x32x16_bf16 v[80:95], v[148:151], v[60:63], v[80:95]
    s_waitcnt lgkmcnt(8)
    ds_read_b64_tr_b16 v[56:57], v18 offset:18432
    ds_read_b64_tr_b16 v[58:59], v18 offset:18944
    ds_read_b64_tr_b16 v[60:61], v19 offset:18432
    ds_read_b64_tr_b16 v[62:63], v19 offset:18944
    v_mfma_f32_32x32x16_bf16 v[64:79], v[152:155], v[240:243], v[64:79]
    v_mfma_f32_32x32x16_bf16 v[80:95], v[152:155], v[244:247], v[80:95]
    s_waitcnt lgkmcnt(8)
    ds_read_b64_tr_b16 v[240:241], v18 offset:20480
    ds_read_b64_tr_b16 v[242:243], v18 offset:20992
    ds_read_b64_tr_b16 v[244:245], v19 offset:20480
    ds_read_b64_tr_b16 v[246:247], v19 offset:20992
    v_mfma_f32_32x32x16_bf16 v[64:79], v[156:159], v[248:251], v[64:79]
    v_mfma_f32_32x32x16_bf16 v[80:95], v[156:159], v[252:255], v[80:95]
    s_waitcnt lgkmcnt(8)
    ds_read_b64_tr_b16 v[248:249], v18 offset:22528
    ds_read_b64_tr_b16 v[250:251], v18 offset:23040
    ds_read_b64_tr_b16 v[252:253], v19 offset:22528
    ds_read_b64_tr_b16 v[254:255], v19 offset:23040
    v_mfma_f32_32x32x16_bf16 v[64:79], v[160:163], v[48:51], v[64:79]
    v_mfma_f32_32x32x16_bf16 v[80:95], v[160:163], v[52:55], v[80:95]
    s_waitcnt lgkmcnt(8)
    ds_read_b64_tr_b16 v[48:49], v18 offset:24576
    ds_read_b64_tr_b16 v[50:51], v18 offset:25088
    ds_read_b64_tr_b16 v[52:53], v19 offset:24576
    ds_read_b64_tr_b16 v[54:55], v19 offset:25088
    v_mfma_f32_32x32x16_bf16 v[64:79], v[164:167], v[56:59], v[64:79]
    v_mfma_f32_32x32x16_bf16 v[80:95], v[164:167], v[60:63], v[80:95]
    s_waitcnt lgkmcnt(8)
    ds_read_b64_tr_b16 v[56:57], v18 offset:26624
    ds_read_b64_tr_b16 v[58:59], v18 offset:27136
    ds_read_b64_tr_b16 v[60:61], v19 offset:26624
    ds_read_b64_tr_b16 v[62:63], v19 offset:27136
    v_mfma_f32_32x32x16_bf16 v[64:79], v[168:171], v[240:243], v[64:79]
    v_mfma_f32_32x32x16_bf16 v[80:95], v[168:171], v[244:247], v[80:95]
    s_waitcnt lgkmcnt(8)
    ds_read_b64_tr_b16 v[240:241], v18 offset:28672
    ds_read_b64_tr_b16 v[242:243], v18 offset:29184
    ds_read_b64_tr_b16 v[244:245], v19 offset:28672
    ds_read_b64_tr_b16 v[246:247], v19 offset:29184
    v_mfma_f32_32x32x16_bf16 v[64:79], v[172:175], v[248:251], v[64:79]
    v_mfma_f32_32x32x16_bf16 v[80:95], v[172:175], v[252:255], v[80:95]
    s_waitcnt lgkmcnt(8)
    ds_read_b64_tr_b16 v[248:249], v18 offset:30720
    ds_read_b64_tr_b16 v[250:251], v18 offset:31232
    ds_read_b64_tr_b16 v[252:253], v19 offset:30720
    ds_read_b64_tr_b16 v[254:255], v19 offset:31232
    v_mfma_f32_32x32x16_bf16 v[64:79], v[176:179], v[48:51], v[64:79]
    v_mfma_f32_32x32x16_bf16 v[80:95], v[176:179], v[52:55], v[80:95]
    s_waitcnt lgkmcnt(8)
    ds_read_b64_tr_b16 v[48:49], v18 offset:32768
    ds_read_b64_tr_b16 v[50:51], v18 offset:33280
    ds_read_b64_tr_b16 v[52:53], v19 offset:32768
    ds_read_b64_tr_b16 v[54:55], v19 offset:33280
    v_mfma_f32_32x32x16_bf16 v[64:79], v[180:183], v[56:59], v[64:79]
    v_mfma_f32_32x32x16_bf16 v[80:95], v[180:183], v[60:63], v[80:95]
    s_waitcnt lgkmcnt(8)
    ds_read_b64_tr_b16 v[56:57], v18 offset:34816
    ds_read_b64_tr_b16 v[58:59], v18 offset:35328
    ds_read_b64_tr_b16 v[60:61], v19 offset:34816
    ds_read_b64_tr_b16 v[62:63], v19 offset:35328
    v_mfma_f32_32x32x16_bf16 v[64:79], v[184:187], v[240:243], v[64:79]
    v_mfma_f32_32x32x16_bf16 v[80:95], v[184:187], v[244:247], v[80:95]
    s_waitcnt lgkmcnt(8)
    ds_read_b64_tr_b16 v[240:241], v18 offset:36864
    ds_read_b64_tr_b16 v[242:243], v18 offset:37376
    ds_read_b64_tr_b16 v[244:245], v19 offset:36864
    ds_read_b64_tr_b16 v[246:247], v19 offset:37376
    v_mfma_f32_32x32x16_bf16 v[64:79], v[188:191], v[248:251], v[64:79]
    v_mfma_f32_32x32x16_bf16 v[80:95], v[188:191], v[252:255], v[80:95]
    s_waitcnt lgkmcnt(8)
    ds_read_b64_tr_b16 v[248:249], v18 offset:38912
    ds_read_b64_tr_b16 v[250:251], v18 offset:39424
    ds_read_b64_tr_b16 v[252:253], v19 offset:38912
    ds_read_b64_tr_b16 v[254:255], v19 offset:39424
    v_mfma_f32_32x32x16_bf16 v[64:79], v[192:195], v[48:51], v[64:79]
    v_mfma_f32_32x32x16_bf16 v[80:95], v[192:195], v[52:55], v[80:95]
    s_waitcnt lgkmcnt(8)
    ds_read_b64_tr_b16 v[48:49], v18 offset:40960
    ds_read_b64_tr_b16 v[50:51], v18 offset:41472
    ds_read_b64_tr_b16 v[52:53], v19 offset:40960
    ds_read_b64_tr_b16 v[54:55], v19 offset:41472
    v_mfma_f32_32x32x16_bf16 v[64:79], v[196:199], v[56:59], v[64:79]
    v_mfma_f32_32x32x16_bf16 v[80:95], v[196:199], v[60:63], v[80:95]
    s_waitcnt lgkmcnt(8)
    ds_read_b64_tr_b16 v[56:57], v18 offset:43008
    ds_read_b64_tr_b16 v[58:59], v18 offset:43520
    ds_read_b64_tr_b16 v[60:61], v19 offset:43008
    ds_read_b64_tr_b16 v[62:63], v19 offset:43520
    v_mfma_f32_32x32x16_bf16 v[64:79], v[200:203], v[240:243], v[64:79]
    v_mfma_f32_32x32x16_bf16 v[80:95], v[200:203], v[244:247], v[80:95]
    s_waitcnt lgkmcnt(8)
    ds_read_b64_tr_b16 v[240:241], v18 offset:45056
    ds_read_b64_tr_b16 v[242:243], v18 offset:45568
    ds_read_b64_tr_b16 v[244:245], v19 offset:45056
    ds_read_b64_tr_b16 v[246:247], v19 offset:45568
    v_mfma_f32_32x32x16_bf16 v[64:79], v[204:207], v[248:251], v[64:79]
    v_mfma_f32_32x32x16_bf16 v[80:95], v[204:207], v[252:255], v[80:95]
    s_waitcnt lgkmcnt(8)
    ds_read_b64_tr_b16 v[248:249], v18 offset:47104
    ds_read_b64_tr_b16 v[250:251], v18 offset:47616
    ds_read_b64_tr_b16 v[252:253], v19 offset:47104
    ds_read_b64_tr_b16 v[254:255], v19 offset:47616
    v_mfma_f32_32x32x16_bf16 v[64:79], v[208:211], v[48:51], v[64:79]
    v_mfma_f32_32x32x16_bf16 v[80:95], v[208:211], v[52:55], v[80:95]
    ds_read_b32 v29, v27 offset:12
    s_waitcnt lgkmcnt(9)
    ds_read_b64_tr_b16 v[48:49], v18 offset:49152
    ds_read_b64_tr_b16 v[50:51], v18 offset:49664
    ds_read_b64_tr_b16 v[52:53], v19 offset:49152
    ds_read_b64_tr_b16 v[54:55], v19 offset:49664
    v_mfma_f32_32x32x16_bf16 v[64:79], v[212:215], v[56:59], v[64:79]
    v_mfma_f32_32x32x16_bf16 v[80:95], v[212:215], v[60:63], v[80:95]
    ds_read_b128 v[32:35], v12 offset:0
    ds_read_b128 v[36:39], v12 offset:32
    s_waitcnt lgkmcnt(12)
    ds_read_b128 v[40:43], v12 offset:64
    ds_read_b128 v[44:47], v12 offset:96
    s_waitcnt lgkmcnt(13)
    ds_read_b64_tr_b16 v[56:57], v18 offset:51200
    ds_read_b64_tr_b16 v[58:59], v18 offset:51712
    s_waitcnt lgkmcnt(12)
    ds_read_b64_tr_b16 v[60:61], v19 offset:51200
    ds_read_b64_tr_b16 v[62:63], v19 offset:51712
    v_mfma_f32_32x32x16_bf16 v[64:79], v[216:219], v[240:243], v[64:79]
    v_mfma_f32_32x32x16_bf16 v[80:95], v[216:219], v[244:247], v[80:95]
    s_waitcnt lgkmcnt(13)
    ds_read_b64_tr_b16 v[240:241], v18 offset:53248
    ds_read_b64_tr_b16 v[242:243], v18 offset:53760
    s_waitcnt lgkmcnt(12)
    ds_read_b64_tr_b16 v[244:245], v19 offset:53248
    ds_read_b64_tr_b16 v[246:247], v19 offset:53760
    v_mfma_f32_32x32x16_bf16 v[64:79], v[220:223], v[248:251], v[64:79]
    v_mfma_f32_32x32x16_bf16 v[80:95], v[220:223], v[252:255], v[80:95]
    s_waitcnt lgkmcnt(12)
    ds_read_b64_tr_b16 v[248:249], v18 offset:55296
    ds_read_b64_tr_b16 v[250:251], v18 offset:55808
    ds_read_b64_tr_b16 v[252:253], v19 offset:55296
    s_waitcnt lgkmcnt(12)
    ds_read_b64_tr_b16 v[254:255], v19 offset:55808
    v_mfma_f32_32x32x16_bf16 v[64:79], v[224:227], v[48:51], v[64:79]
    v_mfma_f32_32x32x16_bf16 v[80:95], v[224:227], v[52:55], v[80:95]
    s_waitcnt lgkmcnt(14)
    v_readfirstlane_b32 s97, v29
    s_nop 0
    s_cmp_lt_u32 s97, 4
    s_cbranch_scc1 AC_10
AC_10_r:
    s_waitcnt lgkmcnt(8)
    ds_read_b64_tr_b16 v[48:49], v20 offset:0
    ds_read_b64_tr_b16 v[50:51], v20 offset:256
    ds_read_b64_tr_b16 v[52:53], v20 offset:1024
    ds_read_b64_tr_b16 v[54:55], v20 offset:1280
    v_mfma_f32_32x32x16_bf16 v[64:79], v[228:231], v[56:59], v[64:79]
    v_mfma_f32_32x32x16_bf16 v[80:95], v[228:231], v[60:63], v[80:95]
    s_waitcnt lgkmcnt(8)
    ds_read_b64_tr_b16 v[56:57], v20 offset:2048
    ds_read_b64_tr_b16 v[58:59], v20 offset:2304
    ds_read_b64_tr_b16 v[60:61], v20 offset:3072
    ds_read_b64_tr_b16 v[62:63], v20 offset:3328
    v_mfma_f32_32x32x16_bf16 v[64:79], v[232:235], v[240:243], v[64:79]
    v_mfma_f32_32x32x16_bf16 v[80:95], v[232:235], v[244:247], v[80:95]
    s_waitcnt lgkmcnt(8)
    ds_read_b64_tr_b16 v[240:241], v20 offset:4096
    ds_read_b64_tr_b16 v[242:243], v20 offset:4352
    ds_read_b64_tr_b16 v[244:245], v20 offset:5120
    ds_read_b64_tr_b16 v[246:247], v20 offset:5376
    s_mov_b64 exec, 1
    ds_add_u32 v27, v30 offset:28
    s_mov_b64 exec, -1
    v_mfma_f32_32x32x16_bf16 v[64:79], v[236:239], v[248:251], v[64:79]
    v_mfma_f32_32x32x16_bf16 v[80:95], v[236:239], v[252:255], v[80:95]
    s_waitcnt lgkmcnt(14)
    s_waitcnt lgkmcnt(9)
    ds_read_b64_tr_b16 v[248:249], v20 offset:6144
    ds_read_b64_tr_b16 v[250:251], v20 offset:6400
    ds_read_b64_tr_b16 v[252:253], v20 offset:7168
    ds_read_b64_tr_b16 v[254:255], v20 offset:7424
    v_mfma_f32_32x32x16_bf16 v[96:111], v[128:131], v[48:51], 0
    v_mfma_f32_32x32x16_bf16 v[96:111], v[132:135], v[52:55], v[96:111]
    s_waitcnt lgkmcnt(9)
    ds_read_b64_tr_b16 v[48:49], v20 offset:8192
    ds_read_b64_tr_b16 v[50:51], v20 offset:8448
    ds_read_b64_tr_b16 v[52:53], v20 offset:9216
    ds_read_b64_tr_b16 v[54:55], v20 offset:9472
    v_mfma_f32_32x32x16_bf16 v[96:111], v[136:139], v[56:59], v[96:111]
    v_mfma_f32_32x32x16_bf16 v[96:111], v[140:143], v[60:63], v[96:111]
    v_mul_f32 v64, v64, v32
    v_mul_f32 v65, v65, v33
    s_waitcnt lgkmcnt(9)
    ds_read_b64_tr_b16 v[56:57], v20 offset:10240
    ds_read_b64_tr_b16 v[58:59], v20 offset:10496
    ds_read_b64_tr_b16 v[60:61], v20 offset:11264
    ds_read_b64_tr_b16 v[62:63], v20 offset:11520
    v_mfma_f32_32x32x16_bf16 v[96:111], v[144:147], v[240:243], v[96:111]
    v_mul_f32 v66, v66, v34
    v_mul_f32 v67, v67, v35
    v_mfma_f32_32x32x16_bf16 v[96:111], v[148:151], v[244:247], v[96:111]
    v_mul_f32 v68, v68, v36
    v_mul_f32 v69, v69, v37
    s_waitcnt lgkmcnt(8)
    ds_read_b64_tr_b16 v[240:241], v20 offset:12288
    ds_read_b64_tr_b16 v[242:243], v20 offset:12544
    ds_read_b64_tr_b16 v[244:245], v20 offset:13312
    ds_read_b64_tr_b16 v[246:247], v20 offset:13568
    v_mfma_f32_32x32x16_bf16 v[96:111], v[152:155], v[248:251], v[96:111]
    v_mul_f32 v70, v70, v38
    v_mul_f32 v71, v71, v39
    v_cvt_pk_bf16_f32 v64, v64, v65
    v_mfma_f32_32x32x16_bf16 v[96:111], v[156:159], v[252:255], v[96:111]
    v_cvt_pk_bf16_f32 v65, v66, v67
    v_cvt_pk_bf16_f32 v66, v68, v69
    s_waitcnt lgkmcnt(8)
    ds_read_b64_tr_b16 v[248:249], v20 offset:14336
    ds_read_b64_tr_b16 v[250:251], v20 offset:14592
    ds_read_b64_tr_b16 v[252:253], v20 offset:15360
    ds_read_b64_tr_b16 v[254:255], v20 offset:15616
    v_mfma_f32_32x32x16_bf16 v[96:111], v[160:163], v[48:51], v[96:111]
    v_cvt_pk_bf16_f32 v67, v70, v71
    buffer_store_dwordx4 v[64:67], v23, s[24:27], s71 offen offset:0 sc1
    v_mfma_f32_32x32x16_bf16 v[96:111], v[164:167], v[52:55], v[96:111]
    v_mul_f32 v72, v72, v40
    v_mul_f32 v73, v73, v41
    s_waitcnt lgkmcnt(8)
    ds_read_b64_tr_b16 v[48:49], v20 offset:16384
    ds_read_b64_tr_b16 v[50:51], v20 offset:16640
    ds_read_b64_tr_b16 v[52:53], v20 offset:17408
    ds_read_b64_tr_b16 v[54:55], v20 offset:17664
    v_mfma_f32_32x32x16_bf16 v[96:111], v[168:171], v[56:59], v[96:111]
    v_mul_f32 v74, v74, v42
    v_mul_f32 v75, v75, v43
    v_mul_f32 v76, v76, v44
    v_mfma_f32_32x32x16_bf16 v[96:111], v[172:175], v[60:63], v[96:111]
    v_mul_f32 v77, v77, v45
    v_mul_f32 v78, v78, v46
    s_waitcnt lgkmcnt(8)
    ds_read_b64_tr_b16 v[56:57], v20 offset:18432
    ds_read_b64_tr_b16 v[58:59], v20 offset:18688
    ds_read_b64_tr_b16 v[60:61], v20 offset:19456
    ds_read_b64_tr_b16 v[62:63], v20 offset:19712
    v_mfma_f32_32x32x16_bf16 v[96:111], v[176:179], v[240:243], v[96:111]
    v_mul_f32 v79, v79, v47
    v_cvt_pk_bf16_f32 v72, v72, v73
    v_mfma_f32_32x32x16_bf16 v[96:111], v[180:183], v[244:247], v[96:111]
    v_cvt_pk_bf16_f32 v73, v74, v75
    v_cvt_pk_bf16_f32 v74, v76, v77
    ds_read_b32 v29, v27 offset:16
    s_waitcnt lgkmcnt(9)
    ds_read_b64_tr_b16 v[240:241], v20 offset:20480
    ds_read_b64_tr_b16 v[242:243], v20 offset:20736
    ds_read_b64_tr_b16 v[244:245], v20 offset:21504
    ds_read_b64_tr_b16 v[246:247], v20 offset:21760
    v_mfma_f32_32x32x16_bf16 v[96:111], v[184:187], v[248:251], v[96:111]
    v_cvt_pk_bf16_f32 v75, v78, v79
    buffer_store_dwordx4 v[72:75], v23, s[24:27], s72 offen offset:0 sc1
    v_mul_f32 v80, v80, v32
    v_mfma_f32_32x32x16_bf16 v[96:111], v[188:191], v[252:255], v[96:111]
    v_mul_f32 v81, v81, v33
    v_mul_f32 v82, v82, v34
    s_waitcnt lgkmcnt(9)
    ds_read_b64_tr_b16 v[248:249], v20 offset:22528
    ds_read_b64_tr_b16 v[250:251], v20 offset:22784
    ds_read_b64_tr_b16 v[252:253], v20 offset:23552
    ds_read_b64_tr_b16 v[254:255], v20 offset:23808
    v_mfma_f32_32x32x16_bf16 v[96:111], v[192:195], v[48:51], v[96:111]
    v_mul_f32 v83, v83, v35
    v_mul_f32 v84, v84, v36
    v_mfma_f32_32x32x16_bf16 v[96:111], v[196:199], v[52:55], v[96:111]
    v_mul_f32 v85, v85, v37
    v_mul_f32 v86, v86, v38
    s_waitcnt lgkmcnt(9)
    ds_read_b64_tr_b16 v[48:49], v20 offset:24576
    ds_read_b64_tr_b16 v[50:51], v20 offset:24832
    ds_read_b64_tr_b16 v[52:53], v20 offset:25600
    ds_read_b64_tr_b16 v[54:55], v20 offset:25856
    v_mfma_f32_32x32x16_bf16 v[96:111], v[200:203], v[56:59], v[96:111]
    v_mul_f32 v87, v87, v39
    v_cvt_pk_bf16_f32 v80, v80, v81
    v_cvt_pk_bf16_f32 v81, v82, v83
    v_mfma_f32_32x32x16_bf16 v[96:111], v[204:207], v[60:63], v[96:111]
    v_cvt_pk_bf16_f32 v82, v84, v85
    v_cvt_pk_bf16_f32 v83, v86, v87
    s_waitcnt lgkmcnt(8)
    ds_read_b64_tr_b16 v[56:57], v20 offset:26624
    ds_read_b64_tr_b16 v[58:59], v20 offset:26880
    ds_read_b64_tr_b16 v[60:61], v20 offset:27648
    ds_read_b64_tr_b16 v[62:63], v20 offset:27904
    v_mfma_f32_32x32x16_bf16 v[96:111], v[208:211], v[240:243], v[96:111]
    buffer_store_dwordx4 v[80:83], v23, s[24:27], s71 offen offset:512 sc1
    v_mul_f32 v88, v88, v40
    v_mfma_f32_32x32x16_bf16 v[96:111], v[212:215], v[244:247], v[96:111]
    v_mul_f32 v89, v89, v41
    v_mul_f32 v90, v90, v42
    s_waitcnt lgkmcnt(14)
    v_readfirstlane_b32 s97, v29
    s_nop 0
    s_cmp_lt_u32 s97, 4
    s_cbranch_scc1 AC_11
AC_11_r:
    s_waitcnt lgkmcnt(8)
    ds_read_b64_tr_b16 v[240:241], v16 offset:0
    ds_read_b64_tr_b16 v[242:243], v16 offset:512
    ds_read_b64_tr_b16 v[244:245], v17 offset:0
    ds_read_b64_tr_b16 v[246:247], v17 offset:512
    v_mfma_f32_32x32x16_bf16 v[96:111], v[216:219], v[248:251], v[96:111]
    v_mul_f32 v91, v91, v43
    v_mul_f32 v92, v92, v44
    v_mul_f32 v93, v93, v45
    v_mfma_f32_32x32x16_bf16 v[96:111], v[220:223], v[252:255], v[96:111]
    v_mul_f32 v94, v94, v46
    v_mul_f32 v95, v95, v47
    s_waitcnt lgkmcnt(8)
    ds_read_b64_tr_b16 v[248:249], v16 offset:2048
    ds_read_b64_tr_b16 v[250:251], v16 offset:2560
    ds_read_b64_tr_b16 v[252:253], v17 offset:2048
    ds_read_b64_tr_b16 v[254:255], v17 offset:2560
    v_mfma_f32_32x32x16_bf16 v[96:111], v[224:227], v[48:51], v[96:111]
    v_cvt_pk_bf16_f32 v88, v88, v89
    v_cvt_pk_bf16_f32 v89, v90, v91
    v_mfma_f32_32x32x16_bf16 v[96:111], v[228:231], v[52:55], v[96:111]
    v_cvt_pk_bf16_f32 v90, v92, v93
    v_cvt_pk_bf16_f32 v91, v94, v95
    buffer_store_dwordx4 v[88:91], v23, s[24:27], s72 offen offset:512 sc1
    s_waitcnt lgkmcnt(8)
    ds_read_b64_tr_b16 v[48:49], v16 offset:4096
    ds_read_b64_tr_b16 v[50:51], v16 offset:4608
    ds_read_b64_tr_b16 v[52:53], v17 offset:4096
    ds_read_b64_tr_b16 v[54:55], v17 offset:4608
    s_mov_b64 exec, 1
    ds_add_u32 v27, v30 offset:32
    s_mov_b64 exec, -1
    v_mfma_f32_32x32x16_bf16 v[96:111], v[232:235], v[56:59], v[96:111]
    v_mfma_f32_32x32x16_bf16 v[96:111], v[236:239], v[60:63], v[96:111]
    s_waitcnt lgkmcnt(9)
    ds_read_b64_tr_b16 v[56:57], v16 offset:6144
    ds_read_b64_tr_b16 v[58:59], v16 offset:6656
    ds_read_b64_tr_b16 v[60:61], v17 offset:6144
    ds_read_b64_tr_b16 v[62:63], v17 offset:6656
    v_mfma_f32_32x32x16_bf16 v[64:79], v[240:243], v[128:131], 0
    v_mfma_f32_32x32x16_bf16 v[80:95], v[244:247], v[128:131], 0
    s_waitcnt lgkmcnt(9)
    ds_read_b64_tr_b16 v[240:241], v16 offset:8192
    ds_read_b64_tr_b16 v[242:243], v16 offset:8704
    ds_read_b64_tr_b16 v[244:245], v17 offset:8192
    ds_read_b64_tr_b16 v[246:247], v17 offset:8704
    v_mfma_f32_32x32x16_bf16 v[64:79], v[248:251], v[132:135], v[64:79]
    v_mfma_f32_32x32x16_bf16 v[80:95], v[252:255], v[132:135], v[80:95]
    v_mul_f32 v96, v96, v32
    v_mul_f32 v97, v97, v33
    v_mul_f32 v98, v98, v34
    s_waitcnt lgkmcnt(9)
    ds_read_b64_tr_b16 v[248:249], v16 offset:10240
    ds_read_b64_tr_b16 v[250:251], v16 offset:10752
    ds_read_b64_tr_b16 v[252:253], v17 offset:10240
    ds_read_b64_tr_b16 v[254:255], v17 offset:10752
    v_mfma_f32_32x32x16_bf16 v[64:79], v[48:51], v[136:139], v[64:79]
    v_mul_f32 v99, v99, v35
    v_mul_f32 v100, v100, v36
    v_mul_f32 v101, v101, v37
    v_mul_f32 v102, v102, v38
    v_mfma_f32_32x32x16_bf16 v[80:95], v[52:55], v[136:139], v[80:95]
    v_mul_f32 v103, v103, v39
    v_cvt_pk_bf16_f32 v96, v96, v97
    v_cvt_pk_bf16_f32 v97, v98, v99
    v_cvt_pk_bf16_f32 v98, v100, v101
    s_waitcnt lgkmcnt(8)
    ds_read_b64_tr_b16 v[48:49], v16 offset:12288
    ds_read_b64_tr_b16 v[50:51], v16 offset:12800
    ds_read_b64_tr_b16 v[52:53], v17 offset:12288
    ds_read_b64_tr_b16 v[54:55], v17 offset:12800
    v_mfma_f32_32x32x16_bf16 v[64:79], v[56:59], v[140:143], v[64:79]
    v_cvt_pk_bf16_f32 v99, v102, v103
    buffer_store_dwordx4 v[96:99], v23, s[24:27], s69 offen offset:0 sc1
    v_mul_f32 v104, v104, v40
    v_mfma_f32_32x32x16_bf16 v[80:95], v[60:63], v[140:143], v[80:95]
    v_mul_f32 v105, v105, v41
    v_mul_f32 v106, v106, v42
    v_mul_f32 v107, v107, v43
    v_mul_f32 v108, v108, v44
    s_waitcnt lgkmcnt(8)
    ds_read_b64_tr_b16 v[56:57], v16 offset:14336
    ds_read_b64_tr_b16 v[58:59], v16 offset:14848
    ds_read_b64_tr_b16 v[60:61], v17 offset:14336
    ds_read_b64_tr_b16 v[62:63], v17 offset:14848
    v_mfma_f32_32x32x16_bf16 v[64:79], v[240:243], v[144:147], v[64:79]
    v_mul_f32 v109, v109, v45
    v_mul_f32 v110, v110, v46
    v_mul_f32 v111, v111, v47
    v_cvt_pk_bf16_f32 v104, v104, v105
    v_mfma_f32_32x32x16_bf16 v[80:95], v[244:247], v[144:147], v[80:95]
    v_cvt_pk_bf16_f32 v105, v106, v107
    v_cvt_pk_bf16_f32 v106, v108, v109
    v_cvt_pk_bf16_f32 v107, v110, v111
    buffer_store_dwordx4 v[104:107], v23, s[24:27], s70 offen offset:0 sc1
    s_waitcnt lgkmcnt(8)
    ds_read_b64_tr_b16 v[240:241], v16 offset:16384
    ds_read_b64_tr_b16 v[242:243], v16 offset:16896
    ds_read_b64_tr_b16 v[244:245], v17 offset:16384
    ds_read_b64_tr_b16 v[246:247], v17 offset:16896
    v_mfma_f32_32x32x16_bf16 v[64:79], v[248:251], v[148:151], v[64:79]
    v_mfma_f32_32x32x16_bf16 v[80:95], v[252:255], v[148:151], v[80:95]
    s_waitcnt lgkmcnt(8)
    ds_read_b64_tr_b16 v[248:249], v16 offset:18432
    ds_read_b64_tr_b16 v[250:251], v16 offset:18944
    ds_read_b64_tr_b16 v[252:253], v17 offset:18432
    ds_read_b64_tr_b16 v[254:255], v17 offset:18944
    v_mfma_f32_32x32x16_bf16 v[64:79], v[48:51], v[152:155], v[64:79]
    v_mfma_f32_32x32x16_bf16 v[80:95], v[52:55], v[152:155], v[80:95]
    s_waitcnt lgkmcnt(8)
    ds_read_b64_tr_b16 v[48:49], v16 offset:20480
    ds_read_b64_tr_b16 v[50:51], v16 offset:20992
    ds_read_b64_tr_b16 v[52:53], v17 offset:20480
    ds_read_b64_tr_b16 v[54:55], v17 offset:20992
    v_mfma_f32_32x32x16_bf16 v[64:79], v[56:59], v[156:159], v[64:79]
    v_mfma_f32_32x32x16_bf16 v[80:95], v[60:63], v[156:159], v[80:95]
    s_waitcnt lgkmcnt(8)
    ds_read_b64_tr_b16 v[56:57], v16 offset:22528
    ds_read_b64_tr_b16 v[58:59], v16 offset:23040
    ds_read_b64_tr_b16 v[60:61], v17 offset:22528
    ds_read_b64_tr_b16 v[62:63], v17 offset:23040
    v_mfma_f32_32x32x16_bf16 v[64:79], v[240:243], v[160:163], v[64:79]
    v_mfma_f32_32x32x16_bf16 v[80:95], v[244:247], v[160:163], v[80:95]
    s_waitcnt lgkmcnt(8)
    ds_read_b64_tr_b16 v[240:241], v16 offset:24576
    ds_read_b64_tr_b16 v[242:243], v16 offset:25088
    ds_read_b64_tr_b16 v[244:245], v17 offset:24576
    ds_read_b64_tr_b16 v[246:247], v17 offset:25088
    v_mfma_f32_32x32x16_bf16 v[64:79], v[248:251], v[164:167], v[64:79]
    v_mfma_f32_32x32x16_bf16 v[80:95], v[252:255], v[164:167], v[80:95]
    s_waitcnt lgkmcnt(8)
    ds_read_b64_tr_b16 v[248:249], v16 offset:26624
    ds_read_b64_tr_b16 v[250:251], v16 offset:27136
    ds_read_b64_tr_b16 v[252:253], v17 offset:26624
    ds_read_b64_tr_b16 v[254:255], v17 offset:27136
    v_mfma_f32_32x32x16_bf16 v[64:79], v[48:51], v[168:171], v[64:79]
    v_mfma_f32_32x32x16_bf16 v[80:95], v[52:55], v[168:171], v[80:95]
    s_waitcnt lgkmcnt(8)
    ds_read_b64_tr_b16 v[48:49], v16 offset:28672
    ds_read_b64_tr_b16 v[50:51], v16 offset:29184
    ds_read_b64_tr_b16 v[52:53], v17 offset:28672
    ds_read_b64_tr_b16 v[54:55], v17 offset:29184
    v_mfma_f32_32x32x16_bf16 v[64:79], v[56:59], v[172:175], v[64:79]
    v_mfma_f32_32x32x16_bf16 v[80:95], v[60:63], v[172:175], v[80:95]
    s_waitcnt lgkmcnt(8)
    ds_read_b64_tr_b16 v[56:57], v16 offset:30720
    ds_read_b64_tr_b16 v[58:59], v16 offset:31232
    ds_read_b64_tr_b16 v[60:61], v17 offset:30720
    ds_read_b64_tr_b16 v[62:63], v17 offset:31232
    v_mfma_f32_32x32x16_bf16 v[64:79], v[240:243], v[176:179], v[64:79]
    v_mfma_f32_32x32x16_bf16 v[80:95], v[244:247], v[176:179], v[80:95]
    s_waitcnt lgkmcnt(8)
    ds_read_b64_tr_b16 v[240:241], v16 offset:32768
    ds_read_b64_tr_b16 v[242:243], v16 offset:33280
    ds_read_b64_tr_b16 v[244:245], v17 offset:32768
    ds_read_b64_tr_b16 v[246:247], v17 offset:33280
    v_mfma_f32_32x32x16_bf16 v[64:79], v[248:251], v[180:183], v[64:79]
    v_mfma_f32_32x32x16_bf16 v[80:95], v[252:255], v[180:183], v[80:95]
    s_waitcnt lgkmcnt(8)
    ds_read_b64_tr_b16 v[248:249], v16 offset:34816
    ds_read_b64_tr_b16 v[250:251], v16 offset:35328
    ds_read_b64_tr_b16 v[252:253], v17 offset:34816
    ds_read_b64_tr_b16 v[254:255], v17 offset:35328
    v_mfma_f32_32x32x16_bf16 v[64:79], v[48:51], v[184:187], v[64:79]
    v_mfma_f32_32x32x16_bf16 v[80:95], v[52:55], v[184:187], v[80:95]
    s_waitcnt lgkmcnt(8)
    ds_read_b64_tr_b16 v[48:49], v16 offset:36864
    ds_read_b64_tr_b16 v[50:51], v16 offset:37376
    ds_read_b64_tr_b16 v[52:53], v17 offset:36864
    ds_read_b64_tr_b16 v[54:55], v17 offset:37376
    v_mfma_f32_32x32x16_bf16 v[64:79], v[56:59], v[188:191], v[64:79]
    v_mfma_f32_32x32x16_bf16 v[80:95], v[60:63], v[188:191], v[80:95]
    s_waitcnt lgkmcnt(8)
    ds_read_b64_tr_b16 v[56:57], v16 offset:38912
    ds_read_b64_tr_b16 v[58:59], v16 offset:39424
    ds_read_b64_tr_b16 v[60:61], v17 offset:38912
    ds_read_b64_tr_b16 v[62:63], v17 offset:39424
    v_mfma_f32_32x32x16_bf16 v[64:79], v[240:243], v[192:195], v[64:79]
    v_mfma_f32_32x32x16_bf16 v[80:95], v[244:247], v[192:195], v[80:95]
    s_waitcnt lgkmcnt(8)
    ds_read_b64_tr_b16 v[240:241], v16 offset:40960
    ds_read_b64_tr_b16 v[242:243], v16 offset:41472
    ds_read_b64_tr_b16 v[244:245], v17 offset:40960
    ds_read_b64_tr_b16 v[246:247], v17 offset:41472
    v_mfma_f32_32x32x16_bf16 v[64:79], v[248:251], v[196:199], v[64:79]
    v_mfma_f32_32x32x16_bf16 v[80:95], v[252:255], v[196:199], v[80:95]
    s_waitcnt lgkmcnt(8)
    ds_read_b64_tr_b16 v[248:249], v16 offset:43008
    ds_read_b64_tr_b16 v[250:251], v16 offset:43520
    ds_read_b64_tr_b16 v[252:253], v17 offset:43008
    ds_read_b64_tr_b16 v[254:255], v17 offset:43520
    v_mfma_f32_32x32x16_bf16 v[64:79], v[48:51], v[200:203], v[64:79]
    v_mfma_f32_32x32x16_bf16 v[80:95], v[52:55], v[200:203], v[80:95]
    s_waitcnt lgkmcnt(8)
    ds_read_b64_tr_b16 v[48:49], v16 offset:45056
    ds_read_b64_tr_b16 v[50:51], v16 offset:45568
    ds_read_b64_tr_b16 v[52:53], v17 offset:45056
    ds_read_b64_tr_b16 v[54:55], v17 offset:45568
    v_mfma_f32_32x32x16_bf16 v[64:79], v[56:59], v[204:207], v[64:79]
    v_mfma_f32_32x32x16_bf16 v[80:95], v[60:63], v[204:207], v[80:95]
    s_waitcnt lgkmcnt(8)
    ds_read_b64_tr_b16 v[56:57], v16 offset:47104
    ds_read_b64_tr_b16 v[58:59], v16 offset:47616
    ds_read_b64_tr_b16 v[60:61], v17 offset:47104
    ds_read_b64_tr_b16 v[62:63], v17 offset:47616
    v_mfma_f32_32x32x16_bf16 v[64:79], v[240:243], v[208:211], v[64:79]
    v_mfma_f32_32x32x16_bf16 v[80:95], v[244:247], v[208:211], v[80:95]
    ds_read_b32 v29, v27 offset:20
    s_waitcnt lgkmcnt(9)
    ds_read_b64_tr_b16 v[240:241], v16 offset:49152
    ds_read_b64_tr_b16 v[242:243], v16 offset:49664
    ds_read_b64_tr_b16 v[244:245], v17 offset:49152
    ds_read_b64_tr_b16 v[246:247], v17 offset:49664
    v_mfma_f32_32x32x16_bf16 v[64:79], v[248:251], v[212:215], v[64:79]
    v_mfma_f32_32x32x16_bf16 v[80:95], v[252:255], v[212:215], v[80:95]
    s_waitcnt lgkmcnt(9)
    ds_read_b64_tr_b16 v[248:249], v16 offset:51200
    ds_read_b64_tr_b16 v[250:251], v16 offset:51712
    ds_read_b64_tr_b16 v[252:253], v17 offset:51200
    ds_read_b64_tr_b16 v[254:255], v17 offset:51712
    v_mfma_f32_32x32x16_bf16 v[64:79], v[48:51], v[216:219], v[64:79]
    v_mfma_f32_32x32x16_bf16 v[80:95], v[52:55], v[216:219], v[80:95]
    s_waitcnt lgkmcnt(9)
    ds_read_b64_tr_b16 v[48:49], v16 offset:53248
    ds_read_b64_tr_b16 v[50:51], v16 offset:53760
    ds_read_b64_tr_b16 v[52:53], v17 offset:53248
    ds_read_b64_tr_b16 v[54:55], v17 offset:53760
    v_mfma_f32_32x32x16_bf16 v[64:79], v[56:59], v[220:223], v[64:79]
    v_mfma_f32_32x32x16_bf16 v[80:95], v[60:63], v[220:223], v[80:95]
    s_waitcnt lgkmcnt(8)
    ds_read_b64_tr_b16 v[56:57], v16 offset:55296
    ds_read_b64_tr_b16 v[58:59], v16 offset:55808
    ds_read_b64_tr_b16 v[60:61], v17 offset:55296
    ds_read_b64_tr_b16 v[62:63], v17 offset:55808
    v_mfma_f32_32x32x16_bf16 v[64:79], v[240:243], v[224:227], v[64:79]
    v_mfma_f32_32x32x16_bf16 v[80:95], v[244:247], v[224:227], v[80:95]
    s_waitcnt lgkmcnt(14)
    v_readfirstlane_b32 s97, v29
    s_nop 0
    s_cmp_lt_u32 s97, 4
    s_cbranch_scc1 AC_13
AC_13_r:
    s_waitcnt lgkmcnt(8)
    ds_read_b64_tr_b16 v[240:241], v18 offset:0
    ds_read_b64_tr_b16 v[242:243], v18 offset:512
    ds_read_b64_tr_b16 v[244:245], v19 offset:0
    ds_read_b64_tr_b16 v[246:247], v19 offset:512
    v_mfma_f32_32x32x16_bf16 v[64:79], v[248:251], v[228:231], v[64:79]
    s_waitcnt vmcnt(0)
    s_mov_b64 exec, 1
    ds_add_rtn_u32 v4, v27, v30 offset:48
    s_mov_b64 exec, -1
    v_mfma_f32_32x32x16_bf16 v[80:95], v[252:255], v[228:231], v[80:95]
    s_waitcnt lgkmcnt(9)
    ds_read_b64_tr_b16 v[248:249], v18 offset:2048
    ds_read_b64_tr_b16 v[250:251], v18 offset:2560
    ds_read_b64_tr_b16 v[252:253], v19 offset:2048
    ds_read_b64_tr_b16 v[254:255], v19 offset:2560
    v_mfma_f32_32x32x16_bf16 v[64:79], v[48:51], v[232:235], v[64:79]
    v_mfma_f32_32x32x16_bf16 v[80:95], v[52:55], v[232:235], v[80:95]
    s_waitcnt lgkmcnt(9)
    ds_read_b64_tr_b16 v[48:49], v18 offset:4096
    ds_read_b64_tr_b16 v[50:51], v18 offset:4608
    ds_read_b64_tr_b16 v[52:53], v19 offset:4096
    ds_read_b64_tr_b16 v[54:55], v19 offset:4608
    s_mov_b64 exec, 1
    ds_add_u32 v27, v30 offset:36
    s_mov_b64 exec, -1
    v_mfma_f32_32x32x16_bf16 v[64:79], v[56:59], v[236:239], v[64:79]
    s_waitcnt lgkmcnt(9)
    v_readfirstlane_b32 s97, v4
    s_nop 0
    s_cmp_lg_u32 s97, 3
    s_cbranch_scc1 FG_12
    s_mov_b64 exec, 1
    buffer_store_dword v6, v5, s[24:27], s75 offen sc1
    s_mov_b64 exec, -1
FG_12:
    v_mfma_f32_32x32x16_bf16 v[80:95], v[60:63], v[236:239], v[80:95]
A_join:
    s_waitcnt lgkmcnt(10)
    ds_read_b64_tr_b16 v[56:57], v18 offset:6144
    ds_read_b64_tr_b16 v[58:59], v18 offset:6656
    ds_read_b64_tr_b16 v[60:61], v19 offset:6144
    ds_read_b64_tr_b16 v[62:63], v19 offset:6656
    v_mfma_f32_32x32x16_bf16 v[96:111], v[240:243], v[128:131], 0
    v_mfma_f32_32x32x16_bf16 v[112:127], v[244:247], v[128:131], 0
    s_waitcnt lgkmcnt(9)
    ds_read_b64_tr_b16 v[240:241], v18 offset:8192
    ds_read_b64_tr_b16 v[242:243], v18 offset:8704
    ds_read_b64_tr_b16 v[244:245], v19 offset:8192
    ds_read_b64_tr_b16 v[246:247], v19 offset:8704
    v_mfma_f32_32x32x16_bf16 v[96:111], v[248:251], v[132:135], v[96:111]
    v_mfma_f32_32x32x16_bf16 v[112:127], v[252:255], v[132:135], v[112:127]
    ds_read_b128 v[32:35], v28 offset:0
    ds_read_b128 v[36:39], v28 offset:32
    s_waitcnt lgkmcnt(12)
    ds_read_b128 v[40:43], v28 offset:64
    ds_read_b128 v[44:47], v28 offset:96
    s_waitcnt lgkmcnt(2)
    v_fma_f32 v64, v64, v25, v32
    v_fma_f32 v65, v65, v25, v33
    v_fma_f32 v66, v66, v25, v34
    v_fma_f32 v67, v67, v25, v35
    s_waitcnt lgkmcnt(13)
    ds_read_b64_tr_b16 v[248:249], v18 offset:10240
    ds_read_b64_tr_b16 v[250:251], v18 offset:10752
    ds_read_b64_tr_b16 v[252:253], v19 offset:10240
    ds_read_b64_tr_b16 v[254:255], v19 offset:10752
    v_mfma_f32_32x32x16_bf16 v[96:111], v[48:51], v[136:139], v[96:111]
    v_fma_f32 v68, v68, v25, v36
    v_fma_f32 v69, v69, v25, v37
    v_fma_f32 v70, v70, v25, v38
    v_fma_f32 v71, v71, v25, v39
    v_mul_f32 v32, v64, v64
    v_mul_f32 v33, v65, v65
    v_mul_f32 v34, v66, v66
    v_mfma_f32_32x32x16_bf16 v[112:127], v[52:55], v[136:139], v[112:127]
    v_mul_f32 v35, v67, v67
    v_mul_f32 v36, v68, v68
    v_mul_f32 v37, v69, v69
    v_mul_f32 v38, v70, v70
    v_mul_f32 v39, v71, v71
    v_fma_f32 v32, v32, s78, v26
    v_fma_f32 v33, v33, s78, v26
    s_waitcnt lgkmcnt(12)
    ds_read_b64_tr_b16 v[48:49], v18 offset:12288
    ds_read_b64_tr_b16 v[50:51], v18 offset:12800
    ds_read_b64_tr_b16 v[52:53], v19 offset:12288
    ds_read_b64_tr_b16 v[54:55], v19 offset:12800
    v_mfma_f32_32x32x16_bf16 v[96:111], v[56:59], v[140:143], v[96:111]
    v_fma_f32 v34, v34, s78, v26
    v_fma_f32 v35, v35, s78, v26
    v_fma_f32 v36, v36, s78, v26
    v_fma_f32 v37, v37, s78, v26
    v_fma_f32 v38, v38, s78, v26
    v_fma_f32 v39, v39, s78, v26
    v_mul_f32 v32, v32, v64
    v_mul_f32 v33, v33, v65
    v_mfma_f32_32x32x16_bf16 v[112:127], v[60:63], v[140:143], v[112:127]
    v_mul_f32 v34, v34, v66
    v_mul_f32 v35, v35, v67
    v_mul_f32 v36, v36, v68
    v_mul_f32 v37, v37, v69
    v_mul_f32 v38, v38, v70
    v_mul_f32 v39, v39, v71
    v_exp_f32 v32, v32
    s_waitcnt lgkmcnt(12)
    ds_read_b64_tr_b16 v[56:57], v18 offset:14336
    ds_read_b64_tr_b16 v[58:59], v18 offset:14848
    ds_read_b64_tr_b16 v[60:61], v19 offset:14336
    ds_read_b64_tr_b16 v[62:63], v19 offset:14848
    v_mfma_f32_32x32x16_bf16 v[96:111], v[240:243], v[144:147], v[96:111]
    v_exp_f32 v33, v33
    v_exp_f32 v34, v34
    v_exp_f32 v35, v35
    v_exp_f32 v36, v36
    v_exp_f32 v37, v37
    v_exp_f32 v38, v38
    v_exp_f32 v39, v39
    v_mfma_f32_32x32x16_bf16 v[112:127], v[244:247], v[144:147], v[112:127]
    v_add_f32 v32, 1.0, v32
    v_add_f32 v33, 1.0, v33
    v_add_f32 v34, 1.0, v34
    v_add_f32 v35, 1.0, v35
    v_add_f32 v36, 1.0, v36
    v_add_f32 v37, 1.0, v37
    v_add_f32 v38, 1.0, v38
    s_waitcnt lgkmcnt(8)
    ds_read_b64_tr_b16 v[240:241], v18 offset:16384
    ds_read_b64_tr_b16 v[242:243], v18 offset:16896
    ds_read_b64_tr_b16 v[244:245], v19 offset:16384
    ds_read_b64_tr_b16 v[246:247], v19 offset:16896
    v_mfma_f32_32x32x16_bf16 v[96:111], v[248:251], v[148:151], v[96:111]
    v_add_f32 v39, 1.0, v39
    v_rcp_f32 v32, v32
    v_rcp_f32 v33, v33
    v_rcp_f32 v34, v34
    v_rcp_f32 v35, v35
    v_rcp_f32 v36, v36
    v_rcp_f32 v37, v37
    v_rcp_f32 v38, v38
    v_mfma_f32_32x32x16_bf16 v[112:127], v[252:255], v[148:151], v[112:127]
    v_rcp_f32 v39, v39
    v_mul_f32 v64, v64, v32
    v_mul_f32 v65, v65, v33
    v_mul_f32 v66, v66, v34
    v_mul_f32 v67, v67, v35
    v_mul_f32 v68, v68, v36
    v_mul_f32 v69, v69, v37
    s_waitcnt lgkmcnt(8)
    ds_read_b64_tr_b16 v[248:249], v18 offset:18432
    ds_read_b64_tr_b16 v[250:251], v18 offset:18944
    ds_read_b64_tr_b16 v[252:253], v19 offset:18432
    ds_read_b64_tr_b16 v[254:255], v19 offset:18944
    v_mfma_f32_32x32x16_bf16 v[96:111], v[48:51], v[152:155], v[96:111]
    v_mul_f32 v70, v70, v38
    v_mul_f32 v71, v71, v39
    v_cvt_pk_bf16_f32 v64, v64, v65
    v_cvt_pk_bf16_f32 v65, v66, v67
    v_cvt_pk_bf16_f32 v66, v68, v69
    v_cvt_pk_bf16_f32 v67, v70, v71
    buffer_store_dwordx4 v[64:67], v22, s[24:27], s73 offen offset:0 sc1
    v_mfma_f32_32x32x16_bf16 v[112:127], v[52:55], v[152:155], v[112:127]
    s_waitcnt lgkmcnt(14)
    v_fma_f32 v72, v72, v25, v40
    v_fma_f32 v73, v73, v25, v41
    v_fma_f32 v74, v74, v25, v42
    v_fma_f32 v75, v75, v25, v43
    v_fma_f32 v76, v76, v25, v44
    v_fma_f32 v77, v77, v25, v45
    v_fma_f32 v78, v78, v25, v46
    s_waitcnt lgkmcnt(8)
    ds_read_b64_tr_b16 v[48:49], v18 offset:20480
    ds_read_b64_tr_b16 v[50:51], v18 offset:20992
    ds_read_b64_tr_b16 v[52:53], v19 offset:20480
    ds_read_b64_tr_b16 v[54:55], v19 offset:20992
    v_mfma_f32_32x32x16_bf16 v[96:111], v[56:59], v[156:159], v[96:111]
    v_fma_f32 v79, v79, v25, v47
    v_mul_f32 v40, v72, v72
    v_mul_f32 v41, v73, v73
    v_mul_f32 v42, v74, v74
    v_mul_f32 v43, v75, v75
    v_mul_f32 v44, v76, v76
    v_mul_f32 v45, v77, v77
    v_mfma_f32_32x32x16_bf16 v[112:127], v[60:63], v[156:159], v[112:127]
    v_mul_f32 v46, v78, v78
    v_mul_f32 v47, v79, v79
    v_fma_f32 v40, v40, s78, v26
    v_fma_f32 v41, v41, s78, v26
    v_fma_f32 v42, v42, s78, v26
    v_fma_f32 v43, v43, s78, v26
    v_fma_f32 v44, v44, s78, v26
    s_waitcnt lgkmcnt(8)
    ds_read_b64_tr_b16 v[56:57], v18 offset:22528
    ds_read_b64_tr_b16 v[58:59], v18 offset:23040
    ds_read_b64_tr_b16 v[60:61], v19 offset:22528
    ds_read_b64_tr_b16 v[62:63], v19 offset:23040
    v_mfma_f32_32x32x16_bf16 v[96:111], v[240:243], v[160:163], v[96:111]
    v_fma_f32 v45, v45, s78, v26
    v_fma_f32 v46, v46, s78, v26
    v_fma_f32 v47, v47, s78, v26
    v_mul_f32 v40, v40, v72
    v_mul_f32 v41, v41, v73
    v_mul_f32 v42, v42, v74
    v_mul_f32 v43, v43, v75
    v_mfma_f32_32x32x16_bf16 v[112:127], v[244:247], v[160:163], v[112:127]
    v_mul_f32 v44, v44, v76
    v_mul_f32 v45, v45, v77
    v_mul_f32 v46, v46, v78
    v_mul_f32 v47, v47, v79
    v_exp_f32 v40, v40
    v_exp_f32 v41, v41
    v_exp_f32 v42, v42
    v_exp_f32 v43, v43
    s_waitcnt lgkmcnt(8)
    ds_read_b64_tr_b16 v[240:241], v18 offset:24576
    ds_read_b64_tr_b16 v[242:243], v18 offset:25088
    ds_read_b64_tr_b16 v[244:245], v19 offset:24576
    ds_read_b64_tr_b16 v[246:247], v19 offset:25088
    v_mfma_f32_32x32x16_bf16 v[96:111], v[248:251], v[164:167], v[96:111]
    v_exp_f32 v44, v44
    v_exp_f32 v45, v45
    v_exp_f32 v46, v46
    v_exp_f32 v47, v47
    v_add_f32 v40, 1.0, v40
    v_add_f32 v41, 1.0, v41
    v_add_f32 v42, 1.0, v42
    v_mfma_f32_32x32x16_bf16 v[112:127], v[252:255], v[164:167], v[112:127]
    v_add_f32 v43, 1.0, v43
    v_add_f32 v44, 1.0, v44
    v_add_f32 v45, 1.0, v45
    v_add_f32 v46, 1.0, v46
    v_add_f32 v47, 1.0, v47
    v_rcp_f32 v40, v40
    v_rcp_f32 v41, v41
    s_waitcnt lgkmcnt(8)
    ds_read_b64_tr_b16 v[248:249], v18 offset:26624
    ds_read_b64_tr_b16 v[250:251], v18 offset:27136
    ds_read_b64_tr_b16 v[252:253], v19 offset:26624
    ds_read_b64_tr_b16 v[254:255], v19 offset:27136
    v_mfma_f32_32x32x16_bf16 v[96:111], v[48:51], v[168:171], v[96:111]
    v_rcp_f32 v42, v42
    v_rcp_f32 v43, v43
    v_rcp_f32 v44, v44
    v_rcp_f32 v45, v45
    v_rcp_f32 v46, v46
    v_rcp_f32 v47, v47
    v_mul_f32 v72, v72, v40
    v_mul_f32 v73, v73, v41
    v_mfma_f32_32x32x16_bf16 v[112:127], v[52:55], v[168:171], v[112:127]
    v_mul_f32 v74, v74, v42
    v_mul_f32 v75, v75, v43
    v_mul_f32 v76, v76, v44
    v_mul_f32 v77, v77, v45
    v_mul_f32 v78, v78, v46
    v_mul_f32 v79, v79, v47
    v_cvt_pk_bf16_f32 v72, v72, v73
    s_waitcnt lgkmcnt(8)
    ds_read_b64_tr_b16 v[48:49], v18 offset:28672
    ds_read_b64_tr_b16 v[50:51], v18 offset:29184
    ds_read_b64_tr_b16 v[52:53], v19 offset:28672
    ds_read_b64_tr_b16 v[54:55], v19 offset:29184
    v_mfma_f32_32x32x16_bf16 v[96:111], v[56:59], v[172:175], v[96:111]
    v_cvt_pk_bf16_f32 v73, v74, v75
    v_cvt_pk_bf16_f32 v74, v76, v77
    v_cvt_pk_bf16_f32 v75, v78, v79
    buffer_store_dwordx4 v[72:75], v22, s[24:27], s73 offen offset:1024 sc1
    ds_read_b128 v[32:35], v28 offset:128
    ds_read_b128 v[36:39], v28 offset:160
    ds_read_b128 v[40:43], v28 offset:192
    s_waitcnt lgkmcnt(12)
    ds_read_b128 v[44:47], v28 offset:224
    s_waitcnt lgkmcnt(2)
    v_mfma_f32_32x32x16_bf16 v[112:127], v[60:63], v[172:175], v[112:127]
    v_fma_f32 v80, v80, v25, v32
    v_fma_f32 v81, v81, v25, v33
    v_fma_f32 v82, v82, v25, v34
    v_fma_f32 v83, v83, v25, v35
    v_fma_f32 v84, v84, v25, v36
    v_fma_f32 v85, v85, v25, v37
    v_fma_f32 v86, v86, v25, v38
    s_waitcnt lgkmcnt(12)
    ds_read_b64_tr_b16 v[56:57], v18 offset:30720
    ds_read_b64_tr_b16 v[58:59], v18 offset:31232
    ds_read_b64_tr_b16 v[60:61], v19 offset:30720
    ds_read_b64_tr_b16 v[62:63], v19 offset:31232
    v_mfma_f32_32x32x16_bf16 v[96:111], v[240:243], v[176:179], v[96:111]
    v_fma_f32 v87, v87, v25, v39
    v_mul_f32 v32, v80, v80
    v_mul_f32 v33, v81, v81
    v_mul_f32 v34, v82, v82
    v_mul_f32 v35, v83, v83
    v_mul_f32 v36, v84, v84
    v_mul_f32 v37, v85, v85
    v_mul_f32 v38, v86, v86
    v_mfma_f32_32x32x16_bf16 v[112:127], v[244:247], v[176:179], v[112:127]
    v_mul_f32 v39, v87, v87
    v_fma_f32 v32, v32, s78, v26
    v_fma_f32 v33, v33, s78, v26
    v_fma_f32 v34, v34, s78, v26
    v_fma_f32 v35, v35, s78, v26
    v_fma_f32 v36, v36, s78, v26
    v_fma_f32 v37, v37, s78, v26
    s_waitcnt lgkmcnt(12)
    ds_read_b64_tr_b16 v[240:241], v18 offset:32768
    ds_read_b64_tr_b16 v[242:243], v18 offset:33280
    ds_read_b64_tr_b16 v[244:245], v19 offset:32768
    ds_read_b64_tr_b16 v[246:247], v19 offset:33280
    v_mfma_f32_32x32x16_bf16 v[96:111], v[248:251], v[180:183], v[96:111]
    v_fma_f32 v38, v38, s78, v26
    v_fma_f32 v39, v39, s78, v26
    v_mul_f32 v32, v32, v80
    v_mul_f32 v33, v33, v81
    v_mul_f32 v34, v34, v82
    v_mul_f32 v35, v35, v83
    v_mul_f32 v36, v36, v84
    v_mfma_f32_32x32x16_bf16 v[112:127], v[252:255], v[180:183], v[112:127]
    v_mul_f32 v37, v37, v85
    v_mul_f32 v38, v38, v86
    v_mul_f32 v39, v39, v87
    v_exp_f32 v32, v32
    v_exp_f32 v33, v33
    v_exp_f32 v34, v34
    v_exp_f32 v35, v35
    v_exp_f32 v36, v36
    s_waitcnt lgkmcnt(12)
    ds_read_b64_tr_b16 v[248:249], v18 offset:34816
    ds_read_b64_tr_b16 v[250:251], v18 offset:35328
    ds_read_b64_tr_b16 v[252:253], v19 offset:34816
    ds_read_b64_tr_b16 v[254:255], v19 offset:35328
    v_mfma_f32_32x32x16_bf16 v[96:111], v[48:51], v[184:187], v[96:111]
    v_exp_f32 v37, v37
    v_exp_f32 v38, v38
    v_exp_f32 v39, v39
    v_add_f32 v32, 1.0, v32
    v_add_f32 v33, 1.0, v33
    v_add_f32 v34, 1.0, v34
    v_add_f32 v35, 1.0, v35
    v_mfma_f32_32x32x16_bf16 v[112:127], v[52:55], v[184:187], v[112:127]
    v_add_f32 v36, 1.0, v36
    v_add_f32 v37, 1.0, v37
    v_add_f32 v38, 1.0, v38
    v_add_f32 v39, 1.0, v39
    v_rcp_f32 v32, v32
    v_rcp_f32 v33, v33
    v_rcp_f32 v34, v34
    s_waitcnt lgkmcnt(8)
    ds_read_b64_tr_b16 v[48:49], v18 offset:36864
    ds_read_b64_tr_b16 v[50:51], v18 offset:37376
    ds_read_b64_tr_b16 v[52:53], v19 offset:36864
    ds_read_b64_tr_b16 v[54:55], v19 offset:37376
    v_mfma_f32_32x32x16_bf16 v[96:111], v[56:59], v[188:191], v[96:111]
    v_rcp_f32 v35, v35
    v_rcp_f32 v36, v36
    v_rcp_f32 v37, v37
    v_rcp_f32 v38, v38
    v_rcp_f32 v39, v39
    v_mul_f32 v80, v80, v32
    v_mul_f32 v81, v81, v33
    v_mfma_f32_32x32x16_bf16 v[112:127], v[60:63], v[188:191], v[112:127]
    v_mul_f32 v82, v82, v34
    v_mul_f32 v83, v83, v35
    v_mul_f32 v84, v84, v36
    v_mul_f32 v85, v85, v37
    v_mul_f32 v86, v86, v38
    v_mul_f32 v87, v87, v39
    v_cvt_pk_bf16_f32 v80, v80, v81
    v_cvt_pk_bf16_f32 v81, v82, v83
    s_waitcnt lgkmcnt(8)
    ds_read_b64_tr_b16 v[56:57], v18 offset:38912
    ds_read_b64_tr_b16 v[58:59], v18 offset:39424
    ds_read_b64_tr_b16 v[60:61], v19 offset:38912
    ds_read_b64_tr_b16 v[62:63], v19 offset:39424
    v_mfma_f32_32x32x16_bf16 v[96:111], v[240:243], v[192:195], v[96:111]
    v_cvt_pk_bf16_f32 v82, v84, v85
    v_cvt_pk_bf16_f32 v83, v86, v87
    buffer_store_dwordx4 v[80:83], v22, s[24:27], s73 offen offset:2048 sc1
    s_waitcnt lgkmcnt(14)
    v_fma_f32 v88, v88, v25, v40
    v_fma_f32 v89, v89, v25, v41
    v_fma_f32 v90, v90, v25, v42
    v_mfma_f32_32x32x16_bf16 v[112:127], v[244:247], v[192:195], v[112:127]
    v_fma_f32 v91, v91, v25, v43
    v_fma_f32 v92, v92, v25, v44
    v_fma_f32 v93, v93, v25, v45
    v_fma_f32 v94, v94, v25, v46
    v_fma_f32 v95, v95, v25, v47
    v_mul_f32 v40, v88, v88
    v_mul_f32 v41, v89, v89
    s_waitcnt lgkmcnt(8)
    ds_read_b64_tr_b16 v[240:241], v18 offset:40960
    ds_read_b64_tr_b16 v[242:243], v18 offset:41472
    ds_read_b64_tr_b16 v[244:245], v19 offset:40960
    ds_read_b64_tr_b16 v[246:247], v19 offset:41472
    v_mfma_f32_32x32x16_bf16 v[96:111], v[248:251], v[196:199], v[96:111]
    v_mul_f32 v42, v90, v90
    v_mul_f32 v43, v91, v91
    v_mul_f32 v44, v92, v92
    v_mul_f32 v45, v93, v93
    v_mul_f32 v46, v94, v94
    v_mul_f32 v47, v95, v95
    v_fma_f32 v40, v40, s78, v26
    v_fma_f32 v41, v41, s78, v26
    v_mfma_f32_32x32x16_bf16 v[112:127], v[252:255], v[196:199], v[112:127]
    v_fma_f32 v42, v42, s78, v26
    v_fma_f32 v43, v43, s78, v26
    v_fma_f32 v44, v44, s78, v26
    v_fma_f32 v45, v45, s78, v26
    v_fma_f32 v46, v46, s78, v26
    v_fma_f32 v47, v47, s78, v26
    v_mul_f32 v40, v40, v88
    s_waitcnt lgkmcnt(8)
    ds_read_b64_tr_b16 v[248:249], v18 offset:43008
    ds_read_b64_tr_b16 v[250:251], v18 offset:43520
    ds_read_b64_tr_b16 v[252:253], v19 offset:43008
    ds_read_b64_tr_b16 v[254:255], v19 offset:43520
    v_mfma_f32_32x32x16_bf16 v[96:111], v[48:51], v[200:203], v[96:111]
    v_mul_f32 v41, v41, v89
    v_mul_f32 v42, v42, v90
    v_mul_f32 v43, v43, v91
    v_mul_f32 v44, v44, v92
    v_mul_f32 v45, v45, v93
    v_mul_f32 v46, v46, v94
    v_mul_f32 v47, v47, v95
    v_mfma_f32_32x32x16_bf16 v[112:127], v[52:55], v[200:203], v[112:127]
    v_exp_f32 v40, v40
    v_exp_f32 v41, v41
    v_exp_f32 v42, v42
    v_exp_f32 v43, v43
    v_exp_f32 v44, v44
    v_exp_f32 v45, v45
    v_exp_f32 v46, v46
    s_waitcnt lgkmcnt(8)
    ds_read_b64_tr_b16 v[48:49], v18 offset:45056
    ds_read_b64_tr_b16 v[50:51], v18 offset:45568
    ds_read_b64_tr_b16 v[52:53], v19 offset:45056
    ds_read_b64_tr_b16 v[54:55], v19 offset:45568
    v_mfma_f32_32x32x16_bf16 v[96:111], v[56:59], v[204:207], v[96:111]
    v_exp_f32 v47, v47
    v_add_f32 v40, 1.0, v40
    v_add_f32 v41, 1.0, v41
    v_add_f32 v42, 1.0, v42
    v_add_f32 v43, 1.0, v43
    v_add_f32 v44, 1.0, v44
    v_add_f32 v45, 1.0, v45
    v_add_f32 v46, 1.0, v46
    v_mfma_f32_32x32x16_bf16 v[112:127], v[60:63], v[204:207], v[112:127]
    v_add_f32 v47, 1.0, v47
    v_rcp_f32 v40, v40
    v_rcp_f32 v41, v41
    v_rcp_f32 v42, v42
    v_rcp_f32 v43, v43
    v_rcp_f32 v44, v44
    v_rcp_f32 v45, v45
    s_waitcnt lgkmcnt(8)
    ds_read_b64_tr_b16 v[56:57], v18 offset:47104
    ds_read_b64_tr_b16 v[58:59], v18 offset:47616
    ds_read_b64_tr_b16 v[60:61], v19 offset:47104
    ds_read_b64_tr_b16 v[62:63], v19 offset:47616
    v_mfma_f32_32x32x16_bf16 v[96:111], v[240:243], v[208:211], v[96:111]
    v_rcp_f32 v46, v46
    v_rcp_f32 v47, v47
    v_mul_f32 v88, v88, v40
    v_mul_f32 v89, v89, v41
    v_mul_f32 v90, v90, v42
    v_mul_f32 v91, v91, v43
    v_mul_f32 v92, v92, v44
    v_mfma_f32_32x32x16_bf16 v[112:127], v[244:247], v[208:211], v[112:127]
    v_mul_f32 v93, v93, v45
    v_mul_f32 v94, v94, v46
    v_mul_f32 v95, v95, v47
    v_cvt_pk_bf16_f32 v88, v88, v89
    v_cvt_pk_bf16_f32 v89, v90, v91
    v_cvt_pk_bf16_f32 v90, v92, v93
    v_cvt_pk_bf16_f32 v91, v94, v95
    buffer_store_dwordx4 v[88:91], v22, s[24:27], s73 offen offset:3072 sc1
    s_waitcnt lgkmcnt(8)
    ds_read_b64_tr_b16 v[240:241], v18 offset:49152
    ds_read_b64_tr_b16 v[242:243], v18 offset:49664
    ds_read_b64_tr_b16 v[244:245], v19 offset:49152
    ds_read_b64_tr_b16 v[246:247], v19 offset:49664
    v_mfma_f32_32x32x16_bf16 v[96:111], v[248:251], v[212:215], v[96:111]
    v_mfma_f32_32x32x16_bf16 v[112:127], v[252:255], v[212:215], v[112:127]
    s_waitcnt lgkmcnt(8)
    ds_read_b64_tr_b16 v[248:249], v18 offset:51200
    ds_read_b64_tr_b16 v[250:251], v18 offset:51712
    ds_read_b64_tr_b16 v[252:253], v19 offset:51200
    ds_read_b64_tr_b16 v[254:255], v19 offset:51712
    v_mfma_f32_32x32x16_bf16 v[96:111], v[48:51], v[216:219], v[96:111]
    v_mfma_f32_32x32x16_bf16 v[112:127], v[52:55], v[216:219], v[112:127]
    s_waitcnt lgkmcnt(8)
    ds_read_b64_tr_b16 v[48:49], v18 offset:53248
    ds_read_b64_tr_b16 v[50:51], v18 offset:53760
    ds_read_b64_tr_b16 v[52:53], v19 offset:53248
    ds_read_b64_tr_b16 v[54:55], v19 offset:53760
    v_mfma_f32_32x32x16_bf16 v[96:111], v[56:59], v[220:223], v[96:111]
    v_mfma_f32_32x32x16_bf16 v[112:127], v[60:63], v[220:223], v[112:127]
    s_waitcnt lgkmcnt(8)
    ds_read_b64_tr_b16 v[56:57], v18 offset:55296
    ds_read_b64_tr_b16 v[58:59], v18 offset:55808
    ds_read_b64_tr_b16 v[60:61], v19 offset:55296
    ds_read_b64_tr_b16 v[62:63], v19 offset:55808
    v_mfma_f32_32x32x16_bf16 v[96:111], v[240:243], v[224:227], v[96:111]
    v_mfma_f32_32x32x16_bf16 v[112:127], v[244:247], v[224:227], v[112:127]
    s_waitcnt lgkmcnt(8)
    v_mfma_f32_32x32x16_bf16 v[96:111], v[248:251], v[228:231], v[96:111]
    v_mfma_f32_32x32x16_bf16 v[112:127], v[252:255], v[228:231], v[112:127]
    s_waitcnt lgkmcnt(4)
    v_mfma_f32_32x32x16_bf16 v[96:111], v[48:51], v[232:235], v[96:111]
    v_mfma_f32_32x32x16_bf16 v[112:127], v[52:55], v[232:235], v[112:127]
    s_waitcnt lgkmcnt(0)
    s_mov_b64 exec, 1
    ds_add_u32 v27, v30 offset:40
    s_mov_b64 exec, -1
    v_mfma_f32_32x32x16_bf16 v[96:111], v[56:59], v[236:239], v[96:111]
    v_mfma_f32_32x32x16_bf16 v[112:127], v[60:63], v[236:239], v[112:127]
    v_mov_b32 v8, v25
    v_mov_b32 v9, v25
    v_mov_b32 v10, s78
    v_mov_b32 v11, s78
    v_mov_b32 v12, v26
    v_mov_b32 v13, v26
    v_mov_b32 v14, 1.0
    v_mov_b32 v15, 1.0
    ds_read_b128 v[32:35], v28 offset:256
    ds_read_b128 v[36:39], v28 offset:288
    ds_read_b128 v[40:43], v28 offset:320
    ds_read_b128 v[44:47], v28 offset:352
    s_waitcnt lgkmcnt(2)
    v_pk_fma_f32 v[96:97], v[96:97], v[8:9], v[32:33]
    v_pk_fma_f32 v[98:99], v[98:99], v[8:9], v[34:35]
    v_pk_fma_f32 v[100:101], v[100:101], v[8:9], v[36:37]
    v_pk_fma_f32 v[102:103], v[102:103], v[8:9], v[38:39]
    v_pk_mul_f32 v[32:33], v[96:97], v[96:97]
    v_pk_mul_f32 v[34:35], v[98:99], v[98:99]
    v_pk_mul_f32 v[36:37], v[100:101], v[100:101]
    v_pk_mul_f32 v[38:39], v[102:103], v[102:103]
    v_pk_fma_f32 v[32:33], v[32:33], v[10:11], v[12:13]
    v_pk_fma_f32 v[34:35], v[34:35], v[10:11], v[12:13]
    v_pk_fma_f32 v[36:37], v[36:37], v[10:11], v[12:13]
    v_pk_fma_f32 v[38:39], v[38:39], v[10:11], v[12:13]
    v_pk_mul_f32 v[32:33], v[32:33], v[96:97]
    v_pk_mul_f32 v[34:35], v[34:35], v[98:99]
    v_pk_mul_f32 v[36:37], v[36:37], v[100:101]
    v_pk_mul_f32 v[38:39], v[38:39], v[102:103]
    v_exp_f32 v32, v32
    v_exp_f32 v33, v33
    v_exp_f32 v34, v34
    v_exp_f32 v35, v35
    v_exp_f32 v36, v36
    v_exp_f32 v37, v37
    v_exp_f32 v38, v38
    v_exp_f32 v39, v39
    v_pk_add_f32 v[32:33], v[32:33], v[14:15]
    v_pk_add_f32 v[34:35], v[34:35], v[14:15]
    v_pk_add_f32 v[36:37], v[36:37], v[14:15]
    v_pk_add_f32 v[38:39], v[38:39], v[14:15]
    v_rcp_f32 v32, v32
    v_rcp_f32 v33, v33
    v_rcp_f32 v34, v34
    v_rcp_f32 v35, v35
    v_rcp_f32 v36, v36
    v_rcp_f32 v37, v37
    v_rcp_f32 v38, v38
    v_rcp_f32 v39, v39
    v_pk_mul_f32 v[96:97], v[96:97], v[32:33]
    v_pk_mul_f32 v[98:99], v[98:99], v[34:35]
    v_pk_mul_f32 v[100:101], v[100:101], v[36:37]
    v_pk_mul_f32 v[102:103], v[102:103], v[38:39]
    v_cvt_pk_bf16_f32 v96, v96, v97
    v_cvt_pk_bf16_f32 v97, v98, v99
    v_cvt_pk_bf16_f32 v98, v100, v101
    v_cvt_pk_bf16_f32 v99, v102, v103
    buffer_store_dwordx4 v[96:99], v22, s[24:27], s74 offen offset:0 sc1
    s_waitcnt lgkmcnt(0)
    v_pk_fma_f32 v[104:105], v[104:105], v[8:9], v[40:41]
    v_pk_fma_f32 v[106:107], v[106:107], v[8:9], v[42:43]
    v_pk_fma_f32 v[108:109], v[108:109], v[8:9], v[44:45]
    v_pk_fma_f32 v[110:111], v[110:111], v[8:9], v[46:47]
    v_pk_mul_f32 v[40:41], v[104:105], v[104:105]
    v_pk_mul_f32 v[42:43], v[106:107], v[106:107]
    v_pk_mul_f32 v[44:45], v[108:109], v[108:109]
    s_waitcnt vmcnt(1)
    s_mov_b64 exec, 1
    ds_add_rtn_u32 v4, v27, v30 offset:52
    s_mov_b64 exec, -1
    v_pk_mul_f32 v[46:47], v[110:111], v[110:111]
    v_pk_fma_f32 v[40:41], v[40:41], v[10:11], v[12:13]
    v_pk_fma_f32 v[42:43], v[42:43], v[10:11], v[12:13]
    v_pk_fma_f32 v[44:45], v[44:45], v[10:11], v[12:13]
    v_pk_fma_f32 v[46:47], v[46:47], v[10:11], v[12:13]
    v_pk_mul_f32 v[40:41], v[40:41], v[104:105]
    v_pk_mul_f32 v[42:43], v[42:43], v[106:107]
    v_pk_mul_f32 v[44:45], v[44:45], v[108:109]
    v_pk_mul_f32 v[46:47], v[46:47], v[110:111]
    v_exp_f32 v40, v40
    s_waitcnt lgkmcnt(0)
    v_readfirstlane_b32 s97, v4
    s_nop 0
    s_cmp_lg_u32 s97, 3
    s_cbranch_scc1 FG_14
    s_mov_b64 exec, 1
    buffer_store_dword v6, v5, s[24:27], s76 offen sc1
    s_mov_b64 exec, -1
FG_14:
    v_exp_f32 v41, v41
    v_exp_f32 v42, v42
    v_exp_f32 v43, v43
    v_exp_f32 v44, v44
    v_exp_f32 v45, v45
    v_exp_f32 v46, v46
    v_exp_f32 v47, v47
    v_pk_add_f32 v[40:41], v[40:41], v[14:15]
    v_pk_add_f32 v[42:43], v[42:43], v[14:15]
    v_pk_add_f32 v[44:45], v[44:45], v[14:15]
    v_pk_add_f32 v[46:47], v[46:47], v[14:15]
    v_rcp_f32 v40, v40
    v_rcp_f32 v41, v41
    v_rcp_f32 v42, v42
    v_rcp_f32 v43, v43
    v_rcp_f32 v44, v44
    v_rcp_f32 v45, v45
    v_rcp_f32 v46, v46
    v_rcp_f32 v47, v47
    v_pk_mul_f32 v[104:105], v[104:105], v[40:41]
    v_pk_mul_f32 v[106:107], v[106:107], v[42:43]
    v_pk_mul_f32 v[108:109], v[108:109], v[44:45]
    v_pk_mul_f32 v[110:111], v[110:111], v[46:47]
    v_cvt_pk_bf16_f32 v104, v104, v105
    v_cvt_pk_bf16_f32 v105, v106, v107
    v_cvt_pk_bf16_f32 v106, v108, v109
    v_cvt_pk_bf16_f32 v107, v110, v111
    buffer_store_dwordx4 v[104:107], v22, s[24:27], s74 offen offset:1024 sc1
    ds_read_b128 v[32:35], v28 offset:384
    ds_read_b128 v[36:39], v28 offset:416
    ds_read_b128 v[40:43], v28 offset:448
    ds_read_b128 v[44:47], v28 offset:480
    s_waitcnt lgkmcnt(2)
    v_pk_fma_f32 v[112:113], v[112:113], v[8:9], v[32:33]
    v_pk_fma_f32 v[114:115], v[114:115], v[8:9], v[34:35]
    v_pk_fma_f32 v[116:117], v[116:117], v[8:9], v[36:37]
    v_pk_fma_f32 v[118:119], v[118:119], v[8:9], v[38:39]
    v_pk_mul_f32 v[32:33], v[112:113], v[112:113]
    v_pk_mul_f32 v[34:35], v[114:115], v[114:115]
    v_pk_mul_f32 v[36:37], v[116:117], v[116:117]
    v_pk_mul_f32 v[38:39], v[118:119], v[118:119]
    v_pk_fma_f32 v[32:33], v[32:33], v[10:11], v[12:13]
    v_pk_fma_f32 v[34:35], v[34:35], v[10:11], v[12:13]
    v_pk_fma_f32 v[36:37], v[36:37], v[10:11], v[12:13]
    v_pk_fma_f32 v[38:39], v[38:39], v[10:11], v[12:13]
    v_pk_mul_f32 v[32:33], v[32:33], v[112:113]
    v_pk_mul_f32 v[34:35], v[34:35], v[114:115]
    v_pk_mul_f32 v[36:37], v[36:37], v[116:117]
    v_pk_mul_f32 v[38:39], v[38:39], v[118:119]
    v_exp_f32 v32, v32
    v_exp_f32 v33, v33
    v_exp_f32 v34, v34
    v_exp_f32 v35, v35
    v_exp_f32 v36, v36
    v_exp_f32 v37, v37
    v_exp_f32 v38, v38
    v_exp_f32 v39, v39
    v_pk_add_f32 v[32:33], v[32:33], v[14:15]
    v_pk_add_f32 v[34:35], v[34:35], v[14:15]
    v_pk_add_f32 v[36:37], v[36:37], v[14:15]
    v_pk_add_f32 v[38:39], v[38:39], v[14:15]
    v_rcp_f32 v32, v32
    v_rcp_f32 v33, v33
    v_rcp_f32 v34, v34
    v_rcp_f32 v35, v35
    v_rcp_f32 v36, v36
    v_rcp_f32 v37, v37
    v_rcp_f32 v38, v38
    v_rcp_f32 v39, v39
    v_pk_mul_f32 v[112:113], v[112:113], v[32:33]
    v_pk_mul_f32 v[114:115], v[114:115], v[34:35]
    v_pk_mul_f32 v[116:117], v[116:117], v[36:37]
    v_pk_mul_f32 v[118:119], v[118:119], v[38:39]
    v_cvt_pk_bf16_f32 v112, v112, v113
    v_cvt_pk_bf16_f32 v113, v114, v115
    v_cvt_pk_bf16_f32 v114, v116, v117
    v_cvt_pk_bf16_f32 v115, v118, v119
    buffer_store_dwordx4 v[112:115], v22, s[24:27], s74 offen offset:2048 sc1
    s_waitcnt lgkmcnt(0)
    v_pk_fma_f32 v[120:121], v[120:121], v[8:9], v[40:41]
    v_pk_fma_f32 v[122:123], v[122:123], v[8:9], v[42:43]
    v_pk_fma_f32 v[124:125], v[124:125], v[8:9], v[44:45]
    v_pk_fma_f32 v[126:127], v[126:127], v[8:9], v[46:47]
    v_pk_mul_f32 v[40:41], v[120:121], v[120:121]
    v_pk_mul_f32 v[42:43], v[122:123], v[122:123]
    v_pk_mul_f32 v[44:45], v[124:125], v[124:125]
    v_pk_mul_f32 v[46:47], v[126:127], v[126:127]
    v_pk_fma_f32 v[40:41], v[40:41], v[10:11], v[12:13]
    v_pk_fma_f32 v[42:43], v[42:43], v[10:11], v[12:13]
    v_pk_fma_f32 v[44:45], v[44:45], v[10:11], v[12:13]
    v_pk_fma_f32 v[46:47], v[46:47], v[10:11], v[12:13]
    v_pk_mul_f32 v[40:41], v[40:41], v[120:121]
    v_pk_mul_f32 v[42:43], v[42:43], v[122:123]
    v_pk_mul_f32 v[44:45], v[44:45], v[124:125]
    v_pk_mul_f32 v[46:47], v[46:47], v[126:127]
    v_exp_f32 v40, v40
    v_exp_f32 v41, v41
    v_exp_f32 v42, v42
    v_exp_f32 v43, v43
    v_exp_f32 v44, v44
    v_exp_f32 v45, v45
    v_exp_f32 v46, v46
    v_exp_f32 v47, v47
    v_pk_add_f32 v[40:41], v[40:41], v[14:15]
    v_pk_add_f32 v[42:43], v[42:43], v[14:15]
    v_pk_add_f32 v[44:45], v[44:45], v[14:15]
    v_pk_add_f32 v[46:47], v[46:47], v[14:15]
    v_rcp_f32 v40, v40
    v_rcp_f32 v41, v41
    v_rcp_f32 v42, v42
    v_rcp_f32 v43, v43
    v_rcp_f32 v44, v44
    v_rcp_f32 v45, v45
    v_rcp_f32 v46, v46
    v_rcp_f32 v47, v47
    v_pk_mul_f32 v[120:121], v[120:121], v[40:41]
    v_pk_mul_f32 v[122:123], v[122:123], v[42:43]
    v_pk_mul_f32 v[124:125], v[124:125], v[44:45]
    v_pk_mul_f32 v[126:127], v[126:127], v[46:47]
    v_cvt_pk_bf16_f32 v120, v120, v121
    v_cvt_pk_bf16_f32 v121, v122, v123
    v_cvt_pk_bf16_f32 v122, v124, v125
    v_cvt_pk_bf16_f32 v123, v126, v127
    buffer_store_dwordx4 v[120:123], v22, s[24:27], s74 offen offset:3072 sc1
    s_mov_b32 s79, 0
    s_branch A_attn
A_helper:
    s_mov_b32 s79, 1
    s_waitcnt lgkmcnt(0)
    s_mul_i32 s55, s44, 0x9E3779B1
    s_add_u32 s55, s55, 0x7F4A7C15
    s_barrier
    v_mov_b32 v6, s55
A_attn:
    v_and_b32 v12, 31, v1
    v_mov_b32 v2, 0xf149f2ca
    v_lshlrev_b32 v3, 2, v24
    v_sub_u32 v3, v12, v3
    v_cmp_le_i32 vcc, 0, v3
    s_nop 1
    v_cndmask_b32 v224, v2, 0, vcc
    v_cndmask_b32 v96, 0, v2, vcc
    v_cmp_le_i32 vcc, 1, v3
    s_nop 1
    v_cndmask_b32 v225, v2, 0, vcc
    v_cndmask_b32 v97, 0, v2, vcc
    v_cmp_le_i32 vcc, 2, v3
    s_nop 1
    v_cndmask_b32 v226, v2, 0, vcc
    v_cndmask_b32 v98, 0, v2, vcc
    v_cmp_le_i32 vcc, 3, v3
    s_nop 1
    v_cndmask_b32 v227, v2, 0, vcc
    v_cndmask_b32 v99, 0, v2, vcc
    v_cmp_le_i32 vcc, 8, v3
    s_nop 1
    v_cndmask_b32 v228, v2, 0, vcc
    v_cndmask_b32 v100, 0, v2, vcc
    v_cmp_le_i32 vcc, 9, v3
    s_nop 1
    v_cndmask_b32 v229, v2, 0, vcc
    v_cndmask_b32 v101, 0, v2, vcc
    v_cmp_le_i32 vcc, 10, v3
    s_nop 1
    v_cndmask_b32 v230, v2, 0, vcc
    v_cndmask_b32 v102, 0, v2, vcc
    v_cmp_le_i32 vcc, 11, v3
    s_nop 1
    v_cndmask_b32 v231, v2, 0, vcc
    v_cndmask_b32 v103, 0, v2, vcc
    v_cmp_le_i32 vcc, 16, v3
    s_nop 1
    v_cndmask_b32 v232, v2, 0, vcc
    v_cndmask_b32 v104, 0, v2, vcc
    v_cmp_le_i32 vcc, 17, v3
    s_nop 1
    v_cndmask_b32 v233, v2, 0, vcc
    v_cndmask_b32 v105, 0, v2, vcc
    v_cmp_le_i32 vcc, 18, v3
    s_nop 1
    v_cndmask_b32 v234, v2, 0, vcc
    v_cndmask_b32 v106, 0, v2, vcc
    v_cmp_le_i32 vcc, 19, v3
    s_nop 1
    v_cndmask_b32 v235, v2, 0, vcc
    v_cndmask_b32 v107, 0, v2, vcc
    v_cmp_le_i32 vcc, 24, v3
    s_nop 1
    v_cndmask_b32 v236, v2, 0, vcc
    v_cndmask_b32 v108, 0, v2, vcc
    v_cmp_le_i32 vcc, 25, v3
    s_nop 1
    v_cndmask_b32 v237, v2, 0, vcc
    v_cndmask_b32 v109, 0, v2, vcc
    v_cmp_le_i32 vcc, 26, v3
    s_nop 1
    v_cndmask_b32 v238, v2, 0, vcc
    v_cndmask_b32 v110, 0, v2, vcc
    v_cmp_le_i32 vcc, 27, v3
    s_nop 1
    v_cndmask_b32 v239, v2, 0, vcc
    v_cndmask_b32 v111, 0, v2, vcc
    s_lshl_b32 s64, s48, 11
    v_add_u32 v14, s64, v21
    v_add_u32 v15, s64, v22
    v_add_u32 v15, 24576, v15
    v_mov_b32 v32, 0x3f803f80
    v_mov_b32 v33, 0
    v_mov_b32 v34, 0
    v_mov_b32 v35, 0
    v_mov_b32 v37, 0
    v_mov_b32 v38, 0
    v_mov_b32 v39, 0
    s_lshl_b32 s66, s52, 2
    s_add_u32 s66, s66, s48
    s_mul_i32 s67, s66, 32768
    s_lshl_b32 s68, s51, 11
    s_add_u32 s67, s67, s68
    s_add_u32 s67, s67, 14680064
    s_lshl_b32 s68, s52, 4
    s_add_u32 s68, s68, s51
    s_lshl_b32 s68, s68, 7
    s_add_u32 s68, s68, 16908288
    ds_read_b32 v29, v27 offset:24
    s_waitcnt lgkmcnt(0)
    v_readfirstlane_b32 s97, v29
    s_nop 0
    s_cmp_ge_u32 s97, 4
    s_cbranch_scc1 A_kvok
    s_cmp_lg_u32 s79, 0
    s_cbranch_scc1 A_nof
    s_waitcnt vmcnt(0)
    s_mov_b64 exec, 1
    ds_add_rtn_u32 v4, v27, v30 offset:56
    s_mov_b64 exec, -1
    s_waitcnt lgkmcnt(0)
    v_readfirstlane_b32 s97, v4
    s_nop 0
    s_cmp_lg_u32 s97, 3
    s_cbranch_scc1 FG_15
    s_mov_b64 exec, 1
    buffer_store_dword v6, v5, s[24:27], s77 offen sc1
    s_mov_b64 exec, -1
FG_15:
    s_mov_b32 s79, 1
A_nof:
    s_mov_b32 s95, 0
LW_16:
    ds_read_b32 v29, v27 offset:24
    s_add_u32 s95, s95, 1
    s_lshr_b32 s94, s95, 18
    s_waitcnt lgkmcnt(0)
    v_readfirstlane_b32 s97, v29
    s_nop 0
    s_add_u32 s97, s97, s94
    s_cmp_ge_u32 s97, 4
    s_cbranch_scc1 LW_16_d
    s_sleep 2
    s_branch LW_16
LW_16_d:
A_kvok:
    ds_read2st64_b64 v[40:43], v14 offset0:96 offset1:97
    ds_read2st64_b64 v[44:47], v14 offset0:98 offset1:99
    ds_read2st64_b64 v[80:83], v14 offset0:0 offset1:1
    ds_read2st64_b64 v[84:87], v14 offset0:2 offset1:3
    ds_read2st64_b64 v[88:91], v14 offset0:4 offset1:5
    ds_read2st64_b64 v[92:95], v14 offset0:6 offset1:7
    ds_read2st64_b64 v[240:243], v14 offset0:8 offset1:9
    ds_read2st64_b64 v[244:247], v14 offset0:10 offset1:11
    ds_read2st64_b64 v[248:251], v14 offset0:12 offset1:13
    ds_read2st64_b64 v[252:255], v14 offset0:14 offset1:15
    s_waitcnt lgkmcnt(6)
    v_mfma_f32_32x32x16_bf16 v[96:111], v[80:83], v[40:43], v[96:111]
    v_mfma_f32_32x32x16_bf16 v[96:111], v[84:87], v[44:47], v[96:111]
    ds_read2st64_b64 v[80:83], v14 offset0:16 offset1:17
    ds_read2st64_b64 v[84:87], v14 offset0:18 offset1:19
    s_waitcnt lgkmcnt(6)
    v_mfma_f32_32x32x16_bf16 v[112:127], v[88:91], v[40:43], 0
    v_mfma_f32_32x32x16_bf16 v[112:127], v[92:95], v[44:47], v[112:127]
    ds_read2st64_b64 v[88:91], v14 offset0:20 offset1:21
    ds_read2st64_b64 v[92:95], v14 offset0:22 offset1:23
    s_waitcnt lgkmcnt(6)
    v_mfma_f32_32x32x16_bf16 v[128:143], v[240:243], v[40:43], 0
    s_nop 2
    v_max_f32 v8, v96, v97
    v_max_f32 v9, v98, v99
    v_max_f32 v10, v100, v101
    v_max_f32 v11, v102, v103
    v_mfma_f32_32x32x16_bf16 v[128:143], v[244:247], v[44:47], v[128:143]
    v_max3_f32 v8, v104, v105, v8
    v_max3_f32 v9, v106, v107, v9
    v_max3_f32 v10, v108, v109, v10
    v_max3_f32 v11, v110, v111, v11
    ds_read2st64_b64 v[240:243], v14 offset0:24 offset1:25
    ds_read2st64_b64 v[244:247], v14 offset0:26 offset1:27
    s_waitcnt lgkmcnt(6)
    v_mfma_f32_32x32x16_bf16 v[144:159], v[248:251], v[40:43], 0
    v_max3_f32 v8, v112, v113, v8
    v_max3_f32 v9, v114, v115, v9
    v_max3_f32 v10, v116, v117, v10
    v_max3_f32 v11, v118, v119, v11
    v_mfma_f32_32x32x16_bf16 v[144:159], v[252:255], v[44:47], v[144:159]
    v_max3_f32 v8, v120, v121, v8
    v_max3_f32 v9, v122, v123, v9
    v_max3_f32 v10, v124, v125, v10
    v_max3_f32 v11, v126, v127, v11
    ds_read2st64_b64 v[248:251], v14 offset0:28 offset1:29
    ds_read2st64_b64 v[252:255], v14 offset0:30 offset1:31
    s_waitcnt lgkmcnt(6)
    v_mfma_f32_32x32x16_bf16 v[160:175], v[80:83], v[40:43], 0
    v_max3_f32 v8, v128, v129, v8
    v_max3_f32 v9, v130, v131, v9
    v_max3_f32 v10, v132, v133, v10
    v_max3_f32 v11, v134, v135, v11
    v_mfma_f32_32x32x16_bf16 v[160:175], v[84:87], v[44:47], v[160:175]
    v_max3_f32 v8, v136, v137, v8
    v_max3_f32 v9, v138, v139, v9
    v_max3_f32 v10, v140, v141, v10
    v_max3_f32 v11, v142, v143, v11
    ds_read2st64_b64 v[80:83], v14 offset0:32 offset1:33
    ds_read2st64_b64 v[84:87], v14 offset0:34 offset1:35
    s_waitcnt lgkmcnt(6)
    v_mfma_f32_32x32x16_bf16 v[176:191], v[88:91], v[40:43], 0
    v_max3_f32 v8, v144, v145, v8
    v_max3_f32 v9, v146, v147, v9
    v_max3_f32 v10, v148, v149, v10
    v_max3_f32 v11, v150, v151, v11
    v_mfma_f32_32x32x16_bf16 v[176:191], v[92:95], v[44:47], v[176:191]
    v_max3_f32 v8, v152, v153, v8
    v_max3_f32 v9, v154, v155, v9
    v_max3_f32 v10, v156, v157, v10
    v_max3_f32 v11, v158, v159, v11
    ds_read_b128 v[88:91], v15 offset:0
    ds_read_b128 v[92:95], v15 offset:1024
    s_waitcnt lgkmcnt(6)
    v_mfma_f32_32x32x16_bf16 v[192:207], v[240:243], v[40:43], 0
    v_max3_f32 v8, v160, v161, v8
    v_max3_f32 v9, v162, v163, v9
    v_max3_f32 v10, v164, v165, v10
    v_max3_f32 v11, v166, v167, v11
    v_mfma_f32_32x32x16_bf16 v[192:207], v[244:247], v[44:47], v[192:207]
    v_max3_f32 v8, v168, v169, v8
    v_max3_f32 v9, v170, v171, v9
    v_max3_f32 v10, v172, v173, v10
    v_max3_f32 v11, v174, v175, v11
    ds_read_b128 v[240:243], v15 offset:2048
    ds_read_b128 v[244:247], v15 offset:3072
    s_waitcnt lgkmcnt(6)
    v_mfma_f32_32x32x16_bf16 v[208:223], v[248:251], v[40:43], 0
    v_max3_f32 v8, v176, v177, v8
    v_max3_f32 v9, v178, v179, v9
    v_max3_f32 v10, v180, v181, v10
    v_max3_f32 v11, v182, v183, v11
    v_mfma_f32_32x32x16_bf16 v[208:223], v[252:255], v[44:47], v[208:223]
    v_max3_f32 v8, v184, v185, v8
    v_max3_f32 v9, v186, v187, v9
    v_max3_f32 v10, v188, v189, v10
    v_max3_f32 v11, v190, v191, v11
    ds_read_b128 v[248:251], v15 offset:4096
    ds_read_b128 v[252:255], v15 offset:5120
    s_waitcnt lgkmcnt(6)
    v_mfma_f32_32x32x16_bf16 v[224:239], v[80:83], v[40:43], v[224:239]
    v_max3_f32 v8, v192, v193, v8
    v_max3_f32 v9, v194, v195, v9
    v_max3_f32 v10, v196, v197, v10
    v_max3_f32 v11, v198, v199, v11
    v_mfma_f32_32x32x16_bf16 v[224:239], v[84:87], v[44:47], v[224:239]
    v_max3_f32 v8, v200, v201, v8
    v_max3_f32 v9, v202, v203, v9
    v_max3_f32 v10, v204, v205, v10
    v_max3_f32 v11, v206, v207, v11
    v_max3_f32 v8, v208, v209, v8
    v_max3_f32 v9, v210, v211, v9
    v_max3_f32 v10, v212, v213, v10
    v_max3_f32 v11, v214, v215, v11
    v_max3_f32 v8, v216, v217, v8
    v_max3_f32 v9, v218, v219, v9
    v_max3_f32 v10, v220, v221, v10
    v_max3_f32 v11, v222, v223, v11
    s_cmp_lg_u32 s79, 0
    s_cbranch_scc1 A_nof2
    s_waitcnt vmcnt(0)
    s_mov_b64 exec, 1
    ds_add_rtn_u32 v4, v27, v30 offset:56
    s_mov_b64 exec, -1
    s_waitcnt lgkmcnt(0)
    v_readfirstlane_b32 s97, v4
    s_nop 0
    s_cmp_lg_u32 s97, 3
    s_cbranch_scc1 FG_17
    s_mov_b64 exec, 1
    buffer_store_dword v6, v5, s[24:27], s77 offen sc1
    s_mov_b64 exec, -1
FG_17:
A_nof2:
    v_max3_f32 v8, v224, v225, v8
    v_max3_f32 v9, v226, v227, v9
    v_max3_f32 v10, v228, v229, v10
    v_max3_f32 v11, v230, v231, v11
    v_max3_f32 v8, v232, v233, v8
    v_max3_f32 v9, v234, v235, v9
    v_max3_f32 v10, v236, v237, v10
    v_max3_f32 v11, v238, v239, v11
    v_max3_f32 v2, v8, v9, v10
    v_max_f32 v2, v2, v11
    v_mov_b32 v3, v2
    s_nop 1
    v_permlane32_swap_b32 v2, v3
    v_max_f32 v2, v2, v3
    v_sub_f32 v2, 0, v2
    v_cvt_pk_bf16_f32 v3, v2, v2
    v_and_b32 v3, 0xffff0000, v3
    v_sub_f32 v3, v2, v3
    v_cvt_pk_bf16_f32 v36, v2, v3
    v_cmp_eq_u32 vcc, 0, v24
    s_nop 1
    v_cndmask_b32 v36, 0, v36, vcc
    s_nop 1
    v_mfma_f32_32x32x16_bf16 v[96:111], v[32:35], v[36:39], v[96:111]
    v_mfma_f32_32x32x16_bf16 v[112:127], v[32:35], v[36:39], v[112:127]
    s_nop 10
    v_exp_f32 v96, v96
    v_exp_f32 v97, v97
    v_exp_f32 v98, v98
    v_exp_f32 v99, v99
    v_mfma_f32_32x32x16_bf16 v[128:143], v[32:35], v[36:39], v[128:143]
    v_exp_f32 v100, v100
    v_exp_f32 v101, v101
    v_exp_f32 v102, v102
    v_exp_f32 v103, v103
    v_exp_f32 v104, v104
    v_exp_f32 v105, v105
    v_exp_f32 v106, v106
    v_exp_f32 v107, v107
    v_exp_f32 v108, v108
    v_exp_f32 v109, v109
    v_exp_f32 v110, v110
    v_exp_f32 v111, v111
    v_cvt_pk_bf16_f32 v64, v96, v97
    v_cvt_pk_bf16_f32 v65, v98, v99
    v_cvt_pk_bf16_f32 v66, v100, v101
    v_cvt_pk_bf16_f32 v67, v102, v103
    v_cvt_pk_bf16_f32 v68, v104, v105
    v_cvt_pk_bf16_f32 v69, v106, v107
    v_cvt_pk_bf16_f32 v70, v108, v109
    v_cvt_pk_bf16_f32 v71, v110, v111
    v_exp_f32 v112, v112
    v_exp_f32 v113, v113
    v_exp_f32 v114, v114
    v_exp_f32 v115, v115
    s_waitcnt lgkmcnt(4)
    v_mfma_f32_32x32x16_bf16 v[48:63], v[88:91], v[64:67], 0
    v_exp_f32 v116, v116
    v_exp_f32 v117, v117
    v_exp_f32 v118, v118
    v_exp_f32 v119, v119
    v_mfma_f32_32x32x16_bf16 v[144:159], v[32:35], v[36:39], v[144:159]
    v_exp_f32 v120, v120
    v_exp_f32 v121, v121
    v_exp_f32 v122, v122
    v_exp_f32 v123, v123
    v_mfma_f32_32x32x16_bf16 v[48:63], v[92:95], v[68:71], v[48:63]
    v_exp_f32 v124, v124
    v_exp_f32 v125, v125
    v_exp_f32 v126, v126
    v_exp_f32 v127, v127
    v_cvt_pk_bf16_f32 v72, v112, v113
    v_cvt_pk_bf16_f32 v73, v114, v115
    v_cvt_pk_bf16_f32 v74, v116, v117
    v_cvt_pk_bf16_f32 v75, v118, v119
    v_cvt_pk_bf16_f32 v76, v120, v121
    v_cvt_pk_bf16_f32 v77, v122, v123
    v_cvt_pk_bf16_f32 v78, v124, v125
    v_cvt_pk_bf16_f32 v79, v126, v127
    ds_read_b128 v[80:83], v15 offset:6144
    ds_read_b128 v[84:87], v15 offset:7168
    v_exp_f32 v128, v128
    v_exp_f32 v129, v129
    v_exp_f32 v130, v130
    v_exp_f32 v131, v131
    s_waitcnt lgkmcnt(4)
    v_mfma_f32_32x32x16_bf16 v[48:63], v[240:243], v[72:75], v[48:63]
    v_exp_f32 v132, v132
    v_exp_f32 v133, v133
    v_exp_f32 v134, v134
    v_exp_f32 v135, v135
    v_mfma_f32_32x32x16_bf16 v[160:175], v[32:35], v[36:39], v[160:175]
    v_exp_f32 v136, v136
    v_exp_f32 v137, v137
    v_exp_f32 v138, v138
    v_exp_f32 v139, v139
    v_mfma_f32_32x32x16_bf16 v[48:63], v[244:247], v[76:79], v[48:63]
    v_exp_f32 v140, v140
    v_exp_f32 v141, v141
    v_exp_f32 v142, v142
    v_exp_f32 v143, v143
    v_cvt_pk_bf16_f32 v64, v128, v129
    v_cvt_pk_bf16_f32 v65, v130, v131
    v_cvt_pk_bf16_f32 v66, v132, v133
    v_cvt_pk_bf16_f32 v67, v134, v135
    v_cvt_pk_bf16_f32 v68, v136, v137
    v_cvt_pk_bf16_f32 v69, v138, v139
    v_cvt_pk_bf16_f32 v70, v140, v141
    v_cvt_pk_bf16_f32 v71, v142, v143
    ds_read_b128 v[88:91], v15 offset:8192
    ds_read_b128 v[92:95], v15 offset:9216
    v_exp_f32 v144, v144
    v_exp_f32 v145, v145
    v_exp_f32 v146, v146
    v_exp_f32 v147, v147
    s_waitcnt lgkmcnt(4)
    v_mfma_f32_32x32x16_bf16 v[48:63], v[248:251], v[64:67], v[48:63]
    v_exp_f32 v148, v148
    v_exp_f32 v149, v149
    v_exp_f32 v150, v150
    v_exp_f32 v151, v151
    v_mfma_f32_32x32x16_bf16 v[176:191], v[32:35], v[36:39], v[176:191]
    v_exp_f32 v152, v152
    v_exp_f32 v153, v153
    v_exp_f32 v154, v154
    v_exp_f32 v155, v155
    v_mfma_f32_32x32x16_bf16 v[48:63], v[252:255], v[68:71], v[48:63]
    v_exp_f32 v156, v156
    v_exp_f32 v157, v157
    v_exp_f32 v158, v158
    v_exp_f32 v159, v159
    v_cvt_pk_bf16_f32 v72, v144, v145
    v_cvt_pk_bf16_f32 v73, v146, v147
    v_cvt_pk_bf16_f32 v74, v148, v149
    v_cvt_pk_bf16_f32 v75, v150, v151
    v_cvt_pk_bf16_f32 v76, v152, v153
    v_cvt_pk_bf16_f32 v77, v154, v155
    v_cvt_pk_bf16_f32 v78, v156, v157
    v_cvt_pk_bf16_f32 v79, v158, v159
    ds_read_b128 v[240:243], v15 offset:10240
    ds_read_b128 v[244:247], v15 offset:11264
    v_exp_f32 v160, v160
    v_exp_f32 v161, v161
    v_exp_f32 v162, v162
    v_exp_f32 v163, v163
    s_waitcnt lgkmcnt(4)
    v_mfma_f32_32x32x16_bf16 v[48:63], v[80:83], v[72:75], v[48:63]
    v_exp_f32 v164, v164
    v_exp_f32 v165, v165
    v_exp_f32 v166, v166
    v_exp_f32 v167, v167
    v_mfma_f32_32x32x16_bf16 v[192:207], v[32:35], v[36:39], v[192:207]
    v_exp_f32 v168, v168
    v_exp_f32 v169, v169
    v_exp_f32 v170, v170
    v_exp_f32 v171, v171
    v_mfma_f32_32x32x16_bf16 v[48:63], v[84:87], v[76:79], v[48:63]
    v_exp_f32 v172, v172
    v_exp_f32 v173, v173
    v_exp_f32 v174, v174
    v_exp_f32 v175, v175
    v_cvt_pk_bf16_f32 v64, v160, v161
    v_cvt_pk_bf16_f32 v65, v162, v163
    v_cvt_pk_bf16_f32 v66, v164, v165
    v_cvt_pk_bf16_f32 v67, v166, v167
    v_cvt_pk_bf16_f32 v68, v168, v169
    v_cvt_pk_bf16_f32 v69, v170, v171
    v_cvt_pk_bf16_f32 v70, v172, v173
    v_cvt_pk_bf16_f32 v71, v174, v175
    ds_read_b128 v[248:251], v15 offset:12288
    ds_read_b128 v[252:255], v15 offset:13312
    v_exp_f32 v176, v176
    v_exp_f32 v177, v177
    v_exp_f32 v178, v178
    v_exp_f32 v179, v179
    s_waitcnt lgkmcnt(4)
    v_mfma_f32_32x32x16_bf16 v[48:63], v[88:91], v[64:67], v[48:63]
    v_exp_f32 v180, v180
    v_exp_f32 v181, v181
    v_exp_f32 v182, v182
    v_exp_f32 v183, v183
    v_mfma_f32_32x32x16_bf16 v[208:223], v[32:35], v[36:39], v[208:223]
    v_exp_f32 v184, v184
    v_exp_f32 v185, v185
    v_exp_f32 v186, v186
    v_exp_f32 v187, v187
    v_mfma_f32_32x32x16_bf16 v[48:63], v[92:95], v[68:71], v[48:63]
    v_exp_f32 v188, v188
    v_exp_f32 v189, v189
    v_exp_f32 v190, v190
    v_exp_f32 v191, v191
    v_cvt_pk_bf16_f32 v72, v176, v177
    v_cvt_pk_bf16_f32 v73, v178, v179
    v_cvt_pk_bf16_f32 v74, v180, v181
    v_cvt_pk_bf16_f32 v75, v182, v183
    v_cvt_pk_bf16_f32 v76, v184, v185
    v_cvt_pk_bf16_f32 v77, v186, v187
    v_cvt_pk_bf16_f32 v78, v188, v189
    v_cvt_pk_bf16_f32 v79, v190, v191
    ds_read_b128 v[80:83], v15 offset:14336
    ds_read_b128 v[84:87], v15 offset:15360
    v_exp_f32 v192, v192
    v_exp_f32 v193, v193
    v_exp_f32 v194, v194
    v_exp_f32 v195, v195
    s_waitcnt lgkmcnt(4)
    v_mfma_f32_32x32x16_bf16 v[48:63], v[240:243], v[72:75], v[48:63]
    v_exp_f32 v196, v196
    v_exp_f32 v197, v197
    v_exp_f32 v198, v198
    v_exp_f32 v199, v199
    v_mfma_f32_32x32x16_bf16 v[224:239], v[32:35], v[36:39], v[224:239]
    v_exp_f32 v200, v200
    v_exp_f32 v201, v201
    v_exp_f32 v202, v202
    v_exp_f32 v203, v203
    v_mfma_f32_32x32x16_bf16 v[48:63], v[244:247], v[76:79], v[48:63]
    v_exp_f32 v204, v204
    v_exp_f32 v205, v205
    v_exp_f32 v206, v206
    v_exp_f32 v207, v207
    v_cvt_pk_bf16_f32 v64, v192, v193
    v_cvt_pk_bf16_f32 v65, v194, v195
    v_cvt_pk_bf16_f32 v66, v196, v197
    v_cvt_pk_bf16_f32 v67, v198, v199
    v_cvt_pk_bf16_f32 v68, v200, v201
    v_cvt_pk_bf16_f32 v69, v202, v203
    v_cvt_pk_bf16_f32 v70, v204, v205
    v_cvt_pk_bf16_f32 v71, v206, v207
    ds_read_b128 v[88:91], v15 offset:16384
    ds_read_b128 v[92:95], v15 offset:17408
    v_exp_f32 v208, v208
    v_exp_f32 v209, v209
    v_exp_f32 v210, v210
    v_exp_f32 v211, v211
    s_waitcnt lgkmcnt(4)
    v_mfma_f32_32x32x16_bf16 v[48:63], v[248:251], v[64:67], v[48:63]
    v_exp_f32 v212, v212
    v_exp_f32 v213, v213
    v_exp_f32 v214, v214
    v_exp_f32 v215, v215
    v_mfma_f32_32x32x16_bf16 v[48:63], v[252:255], v[68:71], v[48:63]
    v_exp_f32 v216, v216
    v_exp_f32 v217, v217
    v_exp_f32 v218, v218
    v_exp_f32 v219, v219
    v_exp_f32 v220, v220
    v_exp_f32 v221, v221
    v_exp_f32 v222, v222
    v_exp_f32 v223, v223
    v_cvt_pk_bf16_f32 v72, v208, v209
    v_cvt_pk_bf16_f32 v73, v210, v211
    v_cvt_pk_bf16_f32 v74, v212, v213
    v_cvt_pk_bf16_f32 v75, v214, v215
    v_cvt_pk_bf16_f32 v76, v216, v217
    v_cvt_pk_bf16_f32 v77, v218, v219
    v_cvt_pk_bf16_f32 v78, v220, v221
    v_cvt_pk_bf16_f32 v79, v222, v223
    v_exp_f32 v224, v224
    v_exp_f32 v225, v225
    v_exp_f32 v226, v226
    v_exp_f32 v227, v227
    s_waitcnt lgkmcnt(2)
    v_mfma_f32_32x32x16_bf16 v[48:63], v[80:83], v[72:75], v[48:63]
    v_exp_f32 v228, v228
    v_exp_f32 v229, v229
    v_exp_f32 v230, v230
    v_exp_f32 v231, v231
    v_mfma_f32_32x32x16_bf16 v[48:63], v[84:87], v[76:79], v[48:63]
    v_exp_f32 v232, v232
    v_exp_f32 v233, v233
    v_exp_f32 v234, v234
    v_exp_f32 v235, v235
    v_exp_f32 v236, v236
    v_exp_f32 v237, v237
    v_exp_f32 v238, v238
    v_exp_f32 v239, v239
    v_cvt_pk_bf16_f32 v64, v224, v225
    v_cvt_pk_bf16_f32 v65, v226, v227
    v_cvt_pk_bf16_f32 v66, v228, v229
    v_cvt_pk_bf16_f32 v67, v230, v231
    v_cvt_pk_bf16_f32 v68, v232, v233
    v_cvt_pk_bf16_f32 v69, v234, v235
    v_cvt_pk_bf16_f32 v70, v236, v237
    v_cvt_pk_bf16_f32 v71, v238, v239
    s_waitcnt lgkmcnt(0)
    v_mfma_f32_32x32x16_bf16 v[48:63], v[88:91], v[64:67], v[48:63]
    v_mfma_f32_32x32x16_bf16 v[48:63], v[92:95], v[68:71], v[48:63]
    s_nop 11
    v_mov_b32 v2, v60
    v_mov_b32 v3, v60
    s_nop 1
    v_permlane32_swap_b32 v2, v3
    v_rcp_f32 v3, v3
    s_nop 0
    v_mul_f32 v48, v48, v3
    v_mul_f32 v49, v49, v3
    v_mul_f32 v50, v50, v3
    v_mul_f32 v51, v51, v3
    v_mul_f32 v52, v52, v3
    v_mul_f32 v53, v53, v3
    v_mul_f32 v54, v54, v3
    v_mul_f32 v55, v55, v3
    v_mul_f32 v56, v56, v3
    v_mul_f32 v57, v57, v3
    v_mul_f32 v58, v58, v3
    v_mul_f32 v59, v59, v3
    v_mul_f32 v60, v60, v3
    v_mul_f32 v61, v61, v3
    v_mul_f32 v62, v62, v3
    v_mul_f32 v63, v63, v3
    v_cvt_pk_bf16_f32 v64, v48, v49
    v_cvt_pk_bf16_f32 v65, v50, v51
    v_cvt_pk_bf16_f32 v66, v52, v53
    v_cvt_pk_bf16_f32 v67, v54, v55
    v_cvt_pk_bf16_f32 v68, v56, v57
    v_cvt_pk_bf16_f32 v69, v58, v59
    v_cvt_pk_bf16_f32 v70, v60, v61
    v_cvt_pk_bf16_f32 v71, v62, v63
    buffer_store_dwordx4 v[64:67], v22, s[24:27], s67 offen sc1
    v_cmp_eq_u32 vcc, 0, v24
    s_nop 1
    v_cndmask_b32 v70, 0, v70, vcc
    v_cndmask_b32 v71, 0, v71, vcc
    buffer_store_dwordx4 v[68:71], v22, s[24:27], s67 offen offset:1024 sc1
    s_waitcnt vmcnt(0)
    s_mov_b64 exec, 1
    ds_add_rtn_u32 v4, v27, v30 offset:60
    s_mov_b64 exec, -1
    s_waitcnt lgkmcnt(0)
    v_readfirstlane_b32 s97, v4
    s_nop 0
    s_cmp_lg_u32 s97, 3
    s_cbranch_scc1 FG_18
    s_mov_b64 exec, 1
    buffer_store_dword v6, v5, s[24:27], s68 offen sc1
    s_mov_b64 exec, -1
FG_18:
    s_endpgm
AC_2:
    s_mov_b32 s95, 0
LW_19:
    ds_read_b32 v29, v27 offset:12
    s_add_u32 s95, s95, 1
    s_lshr_b32 s94, s95, 18
    s_waitcnt lgkmcnt(0)
    v_readfirstlane_b32 s97, v29
    s_nop 0
    s_add_u32 s97, s97, s94
    s_cmp_ge_u32 s97, 4
    s_cbranch_scc1 LW_19_d
    s_sleep 2
    s_branch LW_19
LW_19_d:
    s_branch AC_2_r
AC_3:
    s_mov_b32 s95, 0
LW_20:
    ds_read_b32 v29, v27 offset:16
    s_add_u32 s95, s95, 1
    s_lshr_b32 s94, s95, 18
    s_waitcnt lgkmcnt(0)
    v_readfirstlane_b32 s97, v29
    s_nop 0
    s_add_u32 s97, s97, s94
    s_cmp_ge_u32 s97, 4
    s_cbranch_scc1 LW_20_d
    s_sleep 2
    s_branch LW_20
LW_20_d:
    s_branch AC_3_r
AC_5:
    s_mov_b32 s95, 0
LW_21:
    ds_read_b32 v29, v27 offset:20
    s_add_u32 s95, s95, 1
    s_lshr_b32 s94, s95, 18
    s_waitcnt lgkmcnt(0)
    v_readfirstlane_b32 s97, v29
    s_nop 0
    s_add_u32 s97, s97, s94
    s_cmp_ge_u32 s97, 4
    s_cbranch_scc1 LW_21_d
    s_sleep 2
    s_branch LW_21
LW_21_d:
    s_branch AC_5_r
AC_6:
    s_mov_b32 s95, 0
LW_22:
    ds_read_b32 v29, v27 offset:12
    s_add_u32 s95, s95, 1
    s_lshr_b32 s94, s95, 18
    s_waitcnt lgkmcnt(0)
    v_readfirstlane_b32 s97, v29
    s_nop 0
    s_add_u32 s97, s97, s94
    s_cmp_ge_u32 s97, 4
    s_cbranch_scc1 LW_22_d
    s_sleep 2
    s_branch LW_22
LW_22_d:
    s_branch AC_6_r
AC_7:
    s_mov_b32 s95, 0
LW_23:
    ds_read_b32 v29, v27 offset:16
    s_add_u32 s95, s95, 1
    s_lshr_b32 s94, s95, 18
    s_waitcnt lgkmcnt(0)
    v_readfirstlane_b32 s97, v29
    s_nop 0
    s_add_u32 s97, s97, s94
    s_cmp_ge_u32 s97, 4
    s_cbranch_scc1 LW_23_d
    s_sleep 2
    s_branch LW_23
LW_23_d:
    s_branch AC_7_r
AC_9:
    s_mov_b32 s95, 0
LW_24:
    ds_read_b32 v29, v27 offset:20
    s_add_u32 s95, s95, 1
    s_lshr_b32 s94, s95, 18
    s_waitcnt lgkmcnt(0)
    v_readfirstlane_b32 s97, v29
    s_nop 0
    s_add_u32 s97, s97, s94
    s_cmp_ge_u32 s97, 4
    s_cbranch_scc1 LW_24_d
    s_sleep 2
    s_branch LW_24
LW_24_d:
    s_branch AC_9_r
AC_10:
    s_mov_b32 s95, 0
LW_25:
    ds_read_b32 v29, v27 offset:12
    s_add_u32 s95, s95, 1
    s_lshr_b32 s94, s95, 18
    s_waitcnt lgkmcnt(0)
    v_readfirstlane_b32 s97, v29
    s_nop 0
    s_add_u32 s97, s97, s94
    s_cmp_ge_u32 s97, 4
    s_cbranch_scc1 LW_25_d
    s_sleep 2
    s_branch LW_25
LW_25_d:
    s_branch AC_10_r
AC_11:
    s_mov_b32 s95, 0
LW_26:
    ds_read_b32 v29, v27 offset:16
    s_add_u32 s95, s95, 1
    s_lshr_b32 s94, s95, 18
    s_waitcnt lgkmcnt(0)
    v_readfirstlane_b32 s97, v29
    s_nop 0
    s_add_u32 s97, s97, s94
    s_cmp_ge_u32 s97, 4
    s_cbranch_scc1 LW_26_d
    s_sleep 2
    s_branch LW_26
LW_26_d:
    s_branch AC_11_r
AC_13:
    s_mov_b32 s95, 0
LW_27:
    ds_read_b32 v29, v27 offset:20
    s_add_u32 s95, s95, 1
    s_lshr_b32 s94, s95, 18
    s_waitcnt lgkmcnt(0)
    v_readfirstlane_b32 s97, v29
    s_nop 0
    s_add_u32 s97, s97, s94
    s_cmp_ge_u32 s97, 4
    s_cbranch_scc1 LW_27_d
    s_sleep 2
    s_branch LW_27
LW_27_d:
    s_branch AC_13_r
B_start:
    s_mov_b32 s12, s66
    s_and_b32 s13, s67, 0xffff
    s_mov_b32 s14, 1204224
    s_mov_b32 s15, 0x00020000
    s_mov_b32 s16, s72
    s_and_b32 s17, s73, 0xffff
    s_mov_b32 s18, 1605632
    s_mov_b32 s19, 0x00020000
    s_mov_b32 s20, s74
    s_and_b32 s21, s75, 0xffff
    s_mov_b32 s22, 3584
    s_mov_b32 s23, 0x00020000
    s_mov_b32 s28, s76
    s_and_b32 s29, s77, 0xffff
    s_mov_b32 s30, 1605632
    s_mov_b32 s31, 0x00020000
    s_mov_b32 s32, s68
    s_and_b32 s33, s69, 0xffff
    s_mov_b32 s34, 401408
    s_mov_b32 s35, 0x00020000
    s_mov_b32 s36, s78
    s_and_b32 s37, s79, 0xffff
    s_mov_b32 s38, 896
    s_mov_b32 s39, 0x00020000
    s_mov_b32 s40, s80
    s_and_b32 s41, s81, 0xffff
    s_mov_b32 s42, 1835008
    s_mov_b32 s43, 0x00020000
    s_barrier
    v_lshrrev_b32 v24, 5, v1
    v_lshlrev_b32 v21, 3, v1
    v_lshlrev_b32 v22, 4, v1
    v_and_b32 v2, 31, v1
    v_mul_u32_u24 v28, 7168, v24
    v_lshl_add_u32 v28, v2, 4, v28
    v_lshrrev_b32 v3, 3, v1
    s_min_u32 s65, s52, 2
    v_min_u32 v3, s65, v3
    v_sub_u32 v3, s52, v3
    v_and_b32 v4, 7, v1
    v_min_u32 v4, 5, v4
    v_lshrrev_b32 v5, 1, v4
    v_mul_u32_u24 v5, 448, v5
    v_and_b32 v4, 1, v4
    v_mul_u32_u24 v4, 27, v4
    s_mul_i32 s65, s51, 28
    v_add3_u32 v4, v4, v5, s65
    v_mul_u32_u24 v4, 683, v4
    v_lshrrev_b32 v4, 16, v4
    v_lshl_add_u32 v4, v3, 4, v4
    v_lshlrev_b32 v7, 7, v4
    v_lshrrev_b32 v2, 3, v1
    v_and_b32 v3, 7, v1
    v_bfe_u32 v4, v2, 1, 1
    v_lshlrev_b32 v4, 2, v4
    v_xor_b32 v5, v3, v4
    v_mul_u32_u24 v6, 2688, v2
    v_lshl_add_u32 v8, v5, 4, v6
    v_mul_u32_u24 v6, 3584, v2
    v_lshl_add_u32 v10, v5, 4, v6
    v_mul_u32_u24 v6, 896, v2
    v_lshl_add_u32 v12, v5, 4, v6
    v_add_u32 v9, 20480, v8
    v_add_u32 v11, 27648, v10
    v_add_u32 v13, 6144, v12
    v_lshrrev_b32 v2, 2, v1
    v_and_b32 v3, 3, v1
    v_mul_u32_u24 v6, 2688, v2
    v_lshl_add_u32 v14, v3, 4, v6
    s_mul_i32 s64, s50, 192
    s_and_b32 s65, s50, 1
    s_lshl_b32 s66, s65, 6
    s_add_u32 s66, s64, s66
    s_xor_b32 s65, s65, 1
    s_lshl_b32 s65, s65, 7
    s_add_u32 s64, s64, s65
    s_mul_i32 s65, s48, 43008
    s_add_u32 s64, s64, s65
    s_add_u32 s66, s66, s65
    s_mul_i32 s67, s48, 57344
    s_lshl_b32 s87, s50, 8
    s_add_u32 s67, s67, s87
    s_add_u32 s68, s67, 128
    s_lshl_b32 s69, s48, 10
    s_lshl_b32 s70, s48, 11
    v_and_b32 v2, 15, v1
    v_bfe_u32 v3, v1, 4, 1
    v_lshrrev_b32 v4, 2, v2
    v_bfe_u32 v5, v2, 1, 1
    v_lshl_add_u32 v5, v3, 1, v5
    v_bfe_u32 v6, v2, 3, 1
    v_lshlrev_b32 v6, 2, v6
    v_xor_b32 v5, v5, v6
    v_lshl_add_u32 v4, v24, 2, v4
    v_lshlrev_b32 v4, 7, v4
    v_and_b32 v6, 1, v2
    v_lshl_add_u32 v4, v6, 3, v4
    v_lshl_add_u32 v2, v5, 4, v4
    v_xor_b32 v5, 4, v5
    v_lshl_add_u32 v3, v5, 4, v4
    s_mul_i32 s71, s48, 7168
    s_add_u32 s71, s71, 114688
    s_lshl_b32 s72, s48, 12
    s_add_u32 s72, s72, 147456
    s_mul_i32 s73, s48, 14336
    s_add_u32 s73, s73, 57344
    v_add_u32 v17, s71, v2
    v_add_u32 v18, s71, v3
    v_add_u32 v19, s72, v2
    v_add_u32 v20, s72, v3
    v_add_u32 v25, s73, v2
    v_add_u32 v26, s73, v3
    s_lshl_b32 s74, s54, 7
    s_mul_i32 s75, s48, 14336
    s_add_u32 s75, s75, s74
    s_lshl_b32 s84, s54, 1
    s_mul_i32 s65, s84, 114688
    s_add_u32 s75, s75, s65
    s_sub_u32 s85, s75, 1605632
    s_mul_i32 s76, s48, 100352
    s_add_u32 s76, s76, s74
    s_mul_i32 s77, s53, 229376
    s_add_u32 s77, s77, s69
    s_add_u32 s77, s77, 6291456
    s_lshl_b32 s65, s84, 13
    s_add_u32 s77, s77, s65
    s_sub_u32 s86, s77, 114688
    v_add_u32 v23, 114688, v22
    s_mul_i32 s78, s53, 65536
    s_lshl_b32 s65, s48, 13
    s_add_u32 s78, s78, s65
    s_add_u32 s78, s78, 14680064
    v_and_b32 v6, 15, v1
    v_min_u32 v4, 13, v6
    v_lshlrev_b32 v4, 7, v4
    v_lshlrev_b32 v6, 7, v6
    s_lshr_b32 s79, s53, 1
    s_lshl_b32 s79, s79, 11
    s_add_u32 s79, s79, 16842752
    s_add_u32 s80, s79, 0x8000
    s_add_u32 s81, s79, 0x10000
    s_mov_b32 s82, 16809984
    v_lshlrev_b32 v15, 2, v1
    s_cmp_ge_u32 s56, 28
    s_cbranch_scc1 B_helper
    s_mov_b32 s95, 0
LW_28:
    ds_read_b32 v29, v27 offset:0
    s_add_u32 s95, s95, 1
    s_lshr_b32 s94, s95, 18
    s_waitcnt lgkmcnt(0)
    v_readfirstlane_b32 s97, v29
    s_nop 0
    s_add_u32 s97, s97, s94
    s_cmp_ge_u32 s97, 4
    s_cbranch_scc1 LW_28_d
    s_sleep 2
    s_branch LW_28
LW_28_d:
    s_mul_i32 s65, s57, 172032
    s_add_u32 s65, s65, s66
    s_add_u32 m0, s70, 57344
    s_nop 0
    buffer_load_dwordx4 v8, s[12:15], s65 offen offset:0 lds
    buffer_load_dwordx4 v9, s[12:15], s65 offen offset:1024 lds
    s_mul_i32 s65, s58, 172032
    s_add_u32 s65, s65, s66
    s_add_u32 m0, s70, 65536
    s_nop 0
    buffer_load_dwordx4 v8, s[12:15], s65 offen offset:0 lds
    buffer_load_dwordx4 v9, s[12:15], s65 offen offset:1024 lds
    s_mul_i32 s65, s59, 172032
    s_add_u32 s65, s65, s66
    s_add_u32 m0, s70, 73728
    s_nop 0
    buffer_load_dwordx4 v8, s[12:15], s65 offen offset:0 lds
    buffer_load_dwordx4 v9, s[12:15], s65 offen offset:1024 lds
    s_mul_i32 s65, s60, 172032
    s_add_u32 s65, s65, s66
    s_add_u32 m0, s70, 81920
    s_nop 0
    buffer_load_dwordx4 v8, s[12:15], s65 offen offset:0 lds
    buffer_load_dwordx4 v9, s[12:15], s65 offen offset:1024 lds
    s_mul_i32 s65, s61, 172032
    s_add_u32 s65, s65, s66
    s_add_u32 m0, s70, 90112
    s_nop 0
    buffer_load_dwordx4 v8, s[12:15], s65 offen offset:0 lds
    buffer_load_dwordx4 v9, s[12:15], s65 offen offset:1024 lds
    s_mul_i32 s65, s62, 172032
    s_add_u32 s65, s65, s66
    s_add_u32 m0, s70, 98304
    s_nop 0
    buffer_load_dwordx4 v8, s[12:15], s65 offen offset:0 lds
    buffer_load_dwordx4 v9, s[12:15], s65 offen offset:1024 lds
    s_mul_i32 s65, s63, 172032
    s_add_u32 s65, s65, s66
    s_add_u32 m0, s70, 106496
    s_nop 0
    buffer_load_dwordx4 v8, s[12:15], s65 offen offset:0 lds
    buffer_load_dwordx4 v9, s[12:15], s65 offen offset:1024 lds
    buffer_load_dword v16, v15, s[20:23], s87 offen
    s_mul_i32 s65, s57, 172032
    s_add_u32 s65, s65, s64
    s_add_u32 m0, s69, 114688
    s_nop 0
    buffer_load_dwordx4 v14, s[12:15], s65 offen lds
    s_mul_i32 s65, s58, 172032
    s_add_u32 s65, s65, s64
    s_add_u32 m0, s69, 118784
    s_nop 0
    buffer_load_dwordx4 v14, s[12:15], s65 offen lds
    s_mul_i32 s65, s59, 172032
    s_add_u32 s65, s65, s64
    s_add_u32 m0, s69, 122880
    s_nop 0
    buffer_load_dwordx4 v14, s[12:15], s65 offen lds
    s_waitcnt vmcnt(3)
    s_mov_b64 exec, 1
    ds_add_u32 v27, v30 offset:8
    s_mov_b64 exec, -1
    s_mul_i32 s65, s60, 172032
    s_add_u32 s65, s65, s64
    s_add_u32 m0, s69, 126976
    s_nop 0
    buffer_load_dwordx4 v14, s[12:15], s65 offen lds
    s_mul_i32 s65, s61, 172032
    s_add_u32 s65, s65, s64
    s_add_u32 m0, s69, 131072
    s_nop 0
    buffer_load_dwordx4 v14, s[12:15], s65 offen lds
    s_mul_i32 s65, s62, 172032
    s_add_u32 s65, s65, s64
    s_add_u32 m0, s69, 135168
    s_nop 0
    buffer_load_dwordx4 v14, s[12:15], s65 offen lds
    s_mul_i32 s65, s63, 172032
    s_add_u32 s65, s65, s64
    s_add_u32 m0, s69, 139264
    s_nop 0
    buffer_load_dwordx4 v14, s[12:15], s65 offen lds
    v_lshlrev_b32 v2, 16, v16
    v_and_b32 v3, 0xffff0000, v16
    v_add_u32 v5, 144384, v21
    ds_write_b64 v5, v[2:3]
    v_add_u32 v16, 32768, v22
    s_mov_b32 s95, 0
LW_29:
    ds_read_b32 v29, v27 offset:4
    s_add_u32 s95, s95, 1
    s_lshr_b32 s94, s95, 18
    s_waitcnt lgkmcnt(0)
    v_readfirstlane_b32 s97, v29
    s_nop 0
    s_add_u32 s97, s97, s94
    s_cmp_ge_u32 s97, 4
    s_cbranch_scc1 LW_29_d
    s_sleep 2
    s_branch LW_29
LW_29_d:
    s_mul_i32 s65, s57, 229376
    s_add_u32 s65, s65, s67
    s_add_u32 m0, s70, 0
    s_nop 0
    buffer_load_dwordx4 v10, s[16:19], s65 offen offset:0 lds
    buffer_load_dwordx4 v11, s[16:19], s65 offen offset:1024 lds
    s_mul_i32 s65, s58, 229376
    s_add_u32 s65, s65, s67
    s_add_u32 m0, s70, 8192
    s_nop 0
    buffer_load_dwordx4 v10, s[16:19], s65 offen offset:0 lds
    buffer_load_dwordx4 v11, s[16:19], s65 offen offset:1024 lds
    s_mul_i32 s65, s59, 229376
    s_add_u32 s65, s65, s67
    s_add_u32 m0, s70, 16384
    s_nop 0
    buffer_load_dwordx4 v10, s[16:19], s65 offen offset:0 lds
    buffer_load_dwordx4 v11, s[16:19], s65 offen offset:1024 lds
    s_waitcnt vmcnt(6)
    s_mov_b64 exec, 1
    ds_add_u32 v27, v30 offset:12
    s_mov_b64 exec, -1
    s_mul_i32 s65, s60, 229376
    s_add_u32 s65, s65, s67
    s_add_u32 m0, s70, 24576
    s_nop 0
    buffer_load_dwordx4 v10, s[16:19], s65 offen offset:0 lds
    buffer_load_dwordx4 v11, s[16:19], s65 offen offset:1024 lds
    s_mul_i32 s65, s61, 229376
    s_add_u32 s65, s65, s67
    s_add_u32 m0, s70, 32768
    s_nop 0
    buffer_load_dwordx4 v10, s[16:19], s65 offen offset:0 lds
    buffer_load_dwordx4 v11, s[16:19], s65 offen offset:1024 lds
    s_mul_i32 s65, s62, 229376
    s_add_u32 s65, s65, s67
    s_add_u32 m0, s70, 40960
    s_nop 0
    buffer_load_dwordx4 v10, s[16:19], s65 offen offset:0 lds
    buffer_load_dwordx4 v11, s[16:19], s65 offen offset:1024 lds
    s_mul_i32 s65, s63, 229376
    s_add_u32 s65, s65, s67
    s_add_u32 m0, s70, 49152
    s_nop 0
    buffer_load_dwordx4 v10, s[16:19], s65 offen offset:0 lds
    buffer_load_dwordx4 v11, s[16:19], s65 offen offset:1024 lds
    v_and_b32 v2, 31, v1
    v_mul_u32_u24 v14, 896, v2
    v_lshl_add_u32 v14, v24, 4, v14
    v_lshlrev_b32 v15, 4, v24
    s_lshl_b32 s45, s53, 1
    s_and_b32 s46, s48, 1
    s_add_u32 s45, s45, s46
    s_mul_i32 s45, s45, 28672
    s_lshr_b32 s46, s48, 1
    s_lshl_b32 s46, s46, 6
    s_add_u32 s46, s46, s74
    s_add_u32 s45, s45, s46
    buffer_load_dwordx4 v[96:99], v14, s[8:11], s45 offen offset:0
    buffer_load_dwordx4 v[104:107], v15, s[36:39], s46 offen offset:0
    buffer_load_dwordx4 v[100:103], v14, s[8:11], s45 offen offset:32
    buffer_load_dwordx4 v[108:111], v15, s[36:39], s46 offen offset:32
    v_mov_b64 v[32:33], 0
    v_mov_b64 v[34:35], 0
    v_mov_b64 v[36:37], 0
    v_mov_b64 v[38:39], 0
    v_mov_b64 v[40:41], 0
    v_mov_b64 v[42:43], 0
    v_mov_b64 v[44:45], 0
    v_mov_b64 v[46:47], 0
    v_mov_b64 v[48:49], 0
    v_mov_b64 v[50:51], 0
    v_mov_b64 v[52:53], 0
    v_mov_b64 v[54:55], 0
    v_mov_b64 v[56:57], 0
    v_mov_b64 v[58:59], 0
    v_mov_b64 v[60:61], 0
    v_mov_b64 v[62:63], 0
    v_mov_b64 v[64:65], 0
    v_mov_b64 v[66:67], 0
    v_mov_b64 v[68:69], 0
    v_mov_b64 v[70:71], 0
    v_mov_b64 v[72:73], 0
    v_mov_b64 v[74:75], 0
    v_mov_b64 v[76:77], 0
    v_mov_b64 v[78:79], 0
    v_mov_b64 v[80:81], 0
    v_mov_b64 v[82:83], 0
    v_mov_b64 v[84:85], 0
    v_mov_b64 v[86:87], 0
    v_mov_b64 v[88:89], 0
    v_mov_b64 v[90:91], 0
    v_mov_b64 v[92:93], 0
    v_mov_b64 v[94:95], 0
    s_waitcnt vmcnt(4)
    s_mov_b64 exec, 1
    ds_add_u32 v27, v30 offset:16
    s_mov_b64 exec, -1
    s_waitcnt vmcnt(0)
    v_lshlrev_b32 v112, 16, v96
    v_lshlrev_b32 v2, 16, v104
    v_add_f32 v112, v112, v2
    v_and_b32 v113, 0xffff0000, v96
    v_and_b32 v3, 0xffff0000, v104
    v_add_f32 v113, v113, v3
    v_lshlrev_b32 v114, 16, v97
    v_lshlrev_b32 v2, 16, v105
    v_add_f32 v114, v114, v2
    v_and_b32 v115, 0xffff0000, v97
    v_and_b32 v3, 0xffff0000, v105
    v_add_f32 v115, v115, v3
    v_lshlrev_b32 v116, 16, v98
    v_lshlrev_b32 v2, 16, v106
    v_add_f32 v116, v116, v2
    v_and_b32 v117, 0xffff0000, v98
    v_and_b32 v3, 0xffff0000, v106
    v_add_f32 v117, v117, v3
    v_lshlrev_b32 v118, 16, v99
    v_lshlrev_b32 v2, 16, v107
    v_add_f32 v118, v118, v2
    v_and_b32 v119, 0xffff0000, v99
    v_and_b32 v3, 0xffff0000, v107
    v_add_f32 v119, v119, v3
    v_permlane32_swap_b32 v112, v116
    v_permlane32_swap_b32 v113, v117
    v_permlane32_swap_b32 v114, v118
    v_permlane32_swap_b32 v115, v119
    v_lshlrev_b32 v120, 16, v100
    v_lshlrev_b32 v2, 16, v108
    v_add_f32 v120, v120, v2
    v_and_b32 v121, 0xffff0000, v100
    v_and_b32 v3, 0xffff0000, v108
    v_add_f32 v121, v121, v3
    v_lshlrev_b32 v122, 16, v101
    v_lshlrev_b32 v2, 16, v109
    v_add_f32 v122, v122, v2
    v_and_b32 v123, 0xffff0000, v101
    v_and_b32 v3, 0xffff0000, v109
    v_add_f32 v123, v123, v3
    v_lshlrev_b32 v124, 16, v102
    v_lshlrev_b32 v2, 16, v110
    v_add_f32 v124, v124, v2
    v_and_b32 v125, 0xffff0000, v102
    v_and_b32 v3, 0xffff0000, v110
    v_add_f32 v125, v125, v3
    v_lshlrev_b32 v126, 16, v103
    v_lshlrev_b32 v2, 16, v111
    v_add_f32 v126, v126, v2
    v_and_b32 v127, 0xffff0000, v103
    v_and_b32 v3, 0xffff0000, v111
    v_add_f32 v127, v127, v3
    v_permlane32_swap_b32 v120, v124
    v_permlane32_swap_b32 v121, v125
    v_permlane32_swap_b32 v122, v126
    v_permlane32_swap_b32 v123, v127
    s_cmp_lg_u32 s48, 0
    s_cbranch_scc1 B_i1
    v_mov_b64 v[32:33], v[112:113]
    v_mov_b64 v[34:35], v[114:115]
    v_mov_b64 v[36:37], v[116:117]
    v_mov_b64 v[38:39], v[118:119]
    v_mov_b64 v[40:41], v[120:121]
    v_mov_b64 v[42:43], v[122:123]
    v_mov_b64 v[44:45], v[124:125]
    v_mov_b64 v[46:47], v[126:127]
    s_branch B_ij
B_i1:
    s_cmp_lg_u32 s48, 1
    s_cbranch_scc1 B_i2
    v_mov_b64 v[48:49], v[112:113]
    v_mov_b64 v[50:51], v[114:115]
    v_mov_b64 v[52:53], v[116:117]
    v_mov_b64 v[54:55], v[118:119]
    v_mov_b64 v[56:57], v[120:121]
    v_mov_b64 v[58:59], v[122:123]
    v_mov_b64 v[60:61], v[124:125]
    v_mov_b64 v[62:63], v[126:127]
    s_branch B_ij
B_i2:
    s_cmp_lg_u32 s48, 2
    s_cbranch_scc1 B_i3
    v_mov_b64 v[64:65], v[112:113]
    v_mov_b64 v[66:67], v[114:115]
    v_mov_b64 v[68:69], v[116:117]
    v_mov_b64 v[70:71], v[118:119]
    v_mov_b64 v[72:73], v[120:121]
    v_mov_b64 v[74:75], v[122:123]
    v_mov_b64 v[76:77], v[124:125]
    v_mov_b64 v[78:79], v[126:127]
    s_branch B_ij
B_i3:
    v_mov_b64 v[80:81], v[112:113]
    v_mov_b64 v[82:83], v[114:115]
    v_mov_b64 v[84:85], v[116:117]
    v_mov_b64 v[86:87], v[118:119]
    v_mov_b64 v[88:89], v[120:121]
    v_mov_b64 v[90:91], v[122:123]
    v_mov_b64 v[92:93], v[124:125]
    v_mov_b64 v[94:95], v[126:127]
B_ij:
    s_mov_b32 s95, 0
LW_30:
    ds_read_b32 v29, v27 offset:28
    s_add_u32 s95, s95, 1
    s_lshr_b32 s94, s95, 18
    s_waitcnt lgkmcnt(0)
    v_readfirstlane_b32 s97, v29
    s_nop 0
    s_add_u32 s97, s97, s94
    s_cmp_ge_u32 s97, 4
    s_cbranch_scc1 LW_30_d
    s_sleep 2
    s_branch LW_30
LW_30_d:
    s_mul_i32 s65, s57, 229376
    s_add_u32 s65, s65, s68
    s_add_u32 m0, s70, 57344
    s_nop 0
    buffer_load_dwordx4 v10, s[16:19], s65 offen offset:0 lds
    buffer_load_dwordx4 v11, s[16:19], s65 offen offset:1024 lds
    s_waitcnt vmcnt(4)
    s_mul_i32 s65, s58, 229376
    s_add_u32 s65, s65, s68
    s_add_u32 m0, s70, 65536
    s_nop 0
    buffer_load_dwordx4 v10, s[16:19], s65 offen offset:0 lds
    buffer_load_dwordx4 v11, s[16:19], s65 offen offset:1024 lds
    s_waitcnt vmcnt(4)
    s_mul_i32 s65, s59, 229376
    s_add_u32 s65, s65, s68
    s_add_u32 m0, s70, 73728
    s_nop 0
    buffer_load_dwordx4 v10, s[16:19], s65 offen offset:0 lds
    buffer_load_dwordx4 v11, s[16:19], s65 offen offset:1024 lds
    s_waitcnt vmcnt(4)
    s_mul_i32 s65, s60, 229376
    s_add_u32 s65, s65, s68
    s_add_u32 m0, s70, 81920
    s_nop 0
    buffer_load_dwordx4 v10, s[16:19], s65 offen offset:0 lds
    buffer_load_dwordx4 v11, s[16:19], s65 offen offset:1024 lds
    s_waitcnt vmcnt(4)
    s_mul_i32 s65, s61, 229376
    s_add_u32 s65, s65, s68
    s_add_u32 m0, s70, 90112
    s_nop 0
    buffer_load_dwordx4 v10, s[16:19], s65 offen offset:0 lds
    buffer_load_dwordx4 v11, s[16:19], s65 offen offset:1024 lds
    s_waitcnt vmcnt(4)
    s_mul_i32 s65, s62, 229376
    s_add_u32 s65, s65, s68
    s_add_u32 m0, s70, 98304
    s_nop 0
    buffer_load_dwordx4 v10, s[16:19], s65 offen offset:0 lds
    buffer_load_dwordx4 v11, s[16:19], s65 offen offset:1024 lds
    s_waitcnt vmcnt(4)
    s_mul_i32 s65, s63, 229376
    s_add_u32 s65, s65, s68
    s_add_u32 m0, s70, 106496
    s_nop 0
    buffer_load_dwordx4 v10, s[16:19], s65 offen offset:0 lds
    buffer_load_dwordx4 v11, s[16:19], s65 offen offset:1024 lds
    s_waitcnt vmcnt(4)
    s_waitcnt vmcnt(0)
    s_mov_b64 exec, 1
    ds_add_u32 v27, v30 offset:20
    s_mov_b64 exec, -1
    s_mov_b32 s95, 0
LW_31:
    ds_read_b32 v29, v27 offset:32
    s_add_u32 s95, s95, 1
    s_lshr_b32 s94, s95, 18
    s_waitcnt lgkmcnt(0)
    v_readfirstlane_b32 s97, v29
    s_nop 0
    s_add_u32 s97, s97, s94
    s_cmp_ge_u32 s97, 4
    s_cbranch_scc1 LW_31_d
    s_sleep 2
    s_branch LW_31
LW_31_d:
    s_cmp_ge_u32 s84, 14
    s_cselect_b32 s65, s85, s75
    s_add_u32 s65, s65, 0
    s_add_u32 m0, s72, 0
    s_nop 0
    buffer_load_dwordx4 v12, s[28:31], s65 offen offset:0 lds
    buffer_load_dwordx4 v13, s[28:31], s65 offen offset:1024 lds
    s_waitcnt vmcnt(6)
    s_cmp_ge_u32 s84, 13
    s_cselect_b32 s65, s85, s75
    s_add_u32 s65, s65, 114688
    s_add_u32 m0, s72, 2048
    s_nop 0
    buffer_load_dwordx4 v12, s[28:31], s65 offen offset:0 lds
    buffer_load_dwordx4 v13, s[28:31], s65 offen offset:1024 lds
    s_waitcnt vmcnt(6)
    s_cmp_ge_u32 s84, 12
    s_cselect_b32 s65, s85, s75
    s_add_u32 s65, s65, 229376
    s_add_u32 m0, s71, 0
    s_nop 0
    buffer_load_dwordx4 v12, s[28:31], s65 offen offset:0 lds
    buffer_load_dwordx4 v13, s[28:31], s65 offen offset:1024 lds
    s_waitcnt vmcnt(6)
    s_cmp_ge_u32 s84, 11
    s_cselect_b32 s65, s85, s75
    s_add_u32 s65, s65, 344064
    s_add_u32 m0, s71, 2048
    s_nop 0
    buffer_load_dwordx4 v12, s[28:31], s65 offen offset:0 lds
    buffer_load_dwordx4 v13, s[28:31], s65 offen offset:1024 lds
    s_waitcnt vmcnt(6)
    s_cmp_ge_u32 s84, 10
    s_cselect_b32 s65, s85, s75
    s_add_u32 s65, s65, 458752
    s_add_u32 m0, s71, 4096
    s_nop 0
    buffer_load_dwordx4 v12, s[28:31], s65 offen offset:0 lds
    buffer_load_dwordx4 v13, s[28:31], s65 offen offset:1024 lds
    s_waitcnt vmcnt(6)
    s_waitcnt vmcnt(8)
    ds_read_b64_tr_b16 v[248:249], v19 offset:0
    ds_read_b64_tr_b16 v[250:251], v19 offset:1024
    ds_read_b64_tr_b16 v[252:253], v20 offset:0
    ds_read_b64_tr_b16 v[254:255], v20 offset:1024
    s_waitcnt lgkmcnt(0)
    s_cmp_ge_u32 s84, 9
    s_cselect_b32 s65, s85, s75
    s_add_u32 s65, s65, 573440
    s_add_u32 m0, s72, 0
    s_nop 0
    buffer_load_dwordx4 v12, s[28:31], s65 offen offset:0 lds
    buffer_load_dwordx4 v13, s[28:31], s65 offen offset:1024 lds
    s_waitcnt vmcnt(6)
    s_waitcnt vmcnt(8)
    ds_read_b64_tr_b16 v[240:241], v19 offset:2048
    ds_read_b64_tr_b16 v[242:243], v19 offset:3072
    ds_read_b64_tr_b16 v[244:245], v20 offset:2048
    ds_read_b64_tr_b16 v[246:247], v20 offset:3072
    s_waitcnt lgkmcnt(0)
    s_cmp_ge_u32 s84, 8
    s_cselect_b32 s65, s85, s75
    s_add_u32 s65, s65, 688128
    s_add_u32 m0, s72, 2048
    s_nop 0
    buffer_load_dwordx4 v12, s[28:31], s65 offen offset:0 lds
    buffer_load_dwordx4 v13, s[28:31], s65 offen offset:1024 lds
    s_waitcnt vmcnt(6)
    s_waitcnt vmcnt(8)
    ds_read_b64_tr_b16 v[232:233], v17 offset:0
    ds_read_b64_tr_b16 v[234:235], v17 offset:1024
    ds_read_b64_tr_b16 v[236:237], v18 offset:0
    ds_read_b64_tr_b16 v[238:239], v18 offset:1024
    s_waitcnt lgkmcnt(0)
    s_cmp_ge_u32 s84, 7
    s_cselect_b32 s65, s85, s75
    s_add_u32 s65, s65, 802816
    s_add_u32 m0, s71, 0
    s_nop 0
    buffer_load_dwordx4 v12, s[28:31], s65 offen offset:0 lds
    buffer_load_dwordx4 v13, s[28:31], s65 offen offset:1024 lds
    s_waitcnt vmcnt(6)
    s_waitcnt vmcnt(8)
    ds_read_b64_tr_b16 v[224:225], v17 offset:2048
    ds_read_b64_tr_b16 v[226:227], v17 offset:3072
    ds_read_b64_tr_b16 v[228:229], v18 offset:2048
    ds_read_b64_tr_b16 v[230:231], v18 offset:3072
    s_waitcnt lgkmcnt(0)
    s_cmp_ge_u32 s84, 6
    s_cselect_b32 s65, s85, s75
    s_add_u32 s65, s65, 917504
    s_add_u32 m0, s71, 2048
    s_nop 0
    buffer_load_dwordx4 v12, s[28:31], s65 offen offset:0 lds
    buffer_load_dwordx4 v13, s[28:31], s65 offen offset:1024 lds
    s_waitcnt vmcnt(6)
    s_waitcnt vmcnt(8)
    ds_read_b64_tr_b16 v[216:217], v17 offset:4096
    ds_read_b64_tr_b16 v[218:219], v17 offset:5120
    ds_read_b64_tr_b16 v[220:221], v18 offset:4096
    ds_read_b64_tr_b16 v[222:223], v18 offset:5120
    s_waitcnt lgkmcnt(0)
    s_cmp_ge_u32 s84, 5
    s_cselect_b32 s65, s85, s75
    s_add_u32 s65, s65, 1032192
    s_add_u32 m0, s71, 4096
    s_nop 0
    buffer_load_dwordx4 v12, s[28:31], s65 offen offset:0 lds
    buffer_load_dwordx4 v13, s[28:31], s65 offen offset:1024 lds
    s_waitcnt vmcnt(6)
    s_mov_b32 s95, 0
LW_32:
    ds_read_b32 v29, v27 offset:36
    s_add_u32 s95, s95, 1
    s_lshr_b32 s94, s95, 18
    s_waitcnt lgkmcnt(0)
    v_readfirstlane_b32 s97, v29
    s_nop 0
    s_add_u32 s97, s97, s94
    s_cmp_ge_u32 s97, 4
    s_cbranch_scc1 LW_32_d
    s_sleep 2
    s_branch LW_32
LW_32_d:
    s_lshl_b32 s88, s52, 2
    s_mul_i32 s89, s48, 3
    s_add_u32 s89, s89, s88
    s_mul_i32 s90, s48, 6144
    v_and_b32 v2, 31, v1
    v_lshl_add_u32 v2, v2, 3, s90
    v_mov_b32 v9, 0
    s_add_u32 s65, s89, 0
    s_cmp_lt_u32 s65, 8
    s_cselect_b32 s65, 0xf149, 0
    v_mov_b32 v8, s65
    ds_write_b64 v2, v[8:9] offset:1792
    s_add_u32 s65, s89, 1
    s_cmp_lt_u32 s65, 8
    s_cselect_b32 s65, 0xf149, 0
    v_mov_b32 v8, s65
    ds_write_b64 v2, v[8:9] offset:3840
    s_add_u32 s65, s89, 2
    s_cmp_lt_u32 s65, 8
    s_cselect_b32 s65, 0xf149, 0
    v_mov_b32 v8, s65
    ds_write_b64 v2, v[8:9] offset:5888
    v_and_b32 v2, 31, v1
    v_lshl_add_u32 v2, v2, 3, s70
    v_mov_b32 v8, 0x3f80
    ds_write_b64 v2, v[8:9] offset:50944
    v_and_b32 v2, 3, v1
    v_cmp_eq_u32 vcc, 0, v2
    v_mov_b32 v3, 0x3f803f80
    s_nop 0
    v_cndmask_b32 v8, 0, v3, vcc
    v_mov_b32 v9, v8
    v_mov_b32 v10, v8
    v_mov_b32 v11, v8
    v_lshrrev_b32 v3, 2, v1
    v_lshlrev_b32 v3, 9, v3
    v_lshl_add_u32 v3, v2, 4, v3
    v_add_u32 v3, s90, v3
    s_mov_b32 exec_hi, 0xffff
    ds_write_b128 v3, v[8:11] offset:25024
    s_mov_b64 exec, -1
    s_mov_b32 s96, 0
GP_33:
    buffer_load_dword v5, v7, s[24:27], s82 offen sc1
    s_waitcnt vmcnt(0)
    v_cmp_ne_u32 vcc, s55, v5
    s_nop 1
    s_cmp_eq_u64 vcc, 0
    s_cbranch_scc1 GP_33_d
    s_sleep 8
    s_add_u32 s96, s96, 1
    s_cmp_lt_u32 s96, 20000
    s_cbranch_scc1 GP_33
GP_33_d:
    s_mul_i32 s91, s51, 1792
    s_add_u32 s65, s88, s48
    s_mul_i32 s65, s65, 57344
    s_add_u32 s65, s65, s91
    s_add_u32 m0, s70, 49152
    s_nop 0
    buffer_load_dwordx4 v22, s[24:27], s65 offen sc1 lds
    s_mov_b32 exec_hi, 0xffff
    buffer_load_dwordx4 v22, s[24:27], s65 offen offset:1024 sc1 lds
    s_mov_b64 exec, -1
    s_add_u32 s92, s89, 0
    s_sub_u32 s93, s92, 8
    s_mul_i32 s65, s93, 57344
    s_add_u32 s65, s65, s91
    s_add_u32 s65, s65, 28672
    s_mul_i32 s93, s93, 28672
    s_mul_i32 s96, s51, 448
    s_add_u32 s93, s93, s96
    s_add_u32 s93, s93, 4194304
    s_cmp_lt_u32 s92, 8
    s_cselect_b32 s65, 0x7fff0000, s65
    s_cselect_b32 s93, 0x7fff0000, s93
    s_add_u32 s92, s93, 13312
    s_add_u32 m0, s90, 0
    s_nop 0
    buffer_load_dwordx4 v22, s[24:27], s65 offen sc1 lds
    s_mov_b32 exec_hi, 0xffff
    buffer_load_dwordx4 v22, s[24:27], s65 offen offset:1024 sc1 lds
    s_mov_b32 exec_lo, 0x0fffffff
    s_mov_b32 exec_hi, 0x0fffffff
    s_add_u32 m0, s90, 24576
    s_nop 0
    buffer_load_dwordx4 v28, s[24:27], s93 offen sc1 lds
    buffer_load_dwordx4 v28, s[24:27], s92 offen offset:1024 sc1 lds
    s_mov_b64 exec, -1
    s_add_u32 s92, s89, 1
    s_sub_u32 s93, s92, 8
    s_mul_i32 s65, s93, 57344
    s_add_u32 s65, s65, s91
    s_add_u32 s65, s65, 28672
    s_mul_i32 s93, s93, 28672
    s_mul_i32 s96, s51, 448
    s_add_u32 s93, s93, s96
    s_add_u32 s93, s93, 4194304
    s_cmp_lt_u32 s92, 8
    s_cselect_b32 s65, 0x7fff0000, s65
    s_cselect_b32 s93, 0x7fff0000, s93
    s_add_u32 s92, s93, 13312
    s_add_u32 m0, s90, 2048
    s_nop 0
    buffer_load_dwordx4 v22, s[24:27], s65 offen sc1 lds
    s_mov_b32 exec_hi, 0xffff
    buffer_load_dwordx4 v22, s[24:27], s65 offen offset:1024 sc1 lds
    s_mov_b32 exec_lo, 0x0fffffff
    s_mov_b32 exec_hi, 0x0fffffff
    s_add_u32 m0, s90, 26624
    s_nop 0
    buffer_load_dwordx4 v28, s[24:27], s93 offen sc1 lds
    buffer_load_dwordx4 v28, s[24:27], s92 offen offset:1024 sc1 lds
    s_mov_b64 exec, -1
    s_add_u32 s92, s89, 2
    s_sub_u32 s93, s92, 8
    s_mul_i32 s65, s93, 57344
    s_add_u32 s65, s65, s91
    s_add_u32 s65, s65, 28672
    s_mul_i32 s93, s93, 28672
    s_mul_i32 s96, s51, 448
    s_add_u32 s93, s93, s96
    s_add_u32 s93, s93, 4194304
    s_cmp_lt_u32 s92, 8
    s_cselect_b32 s65, 0x7fff0000, s65
    s_cselect_b32 s93, 0x7fff0000, s93
    s_add_u32 s92, s93, 13312
    s_add_u32 m0, s90, 4096
    s_nop 0
    buffer_load_dwordx4 v22, s[24:27], s65 offen sc1 lds
    s_mov_b32 exec_hi, 0xffff
    buffer_load_dwordx4 v22, s[24:27], s65 offen offset:1024 sc1 lds
    s_mov_b32 exec_lo, 0x0fffffff
    s_mov_b32 exec_hi, 0x0fffffff
    s_add_u32 m0, s90, 28672
    s_nop 0
    buffer_load_dwordx4 v28, s[24:27], s93 offen sc1 lds
    buffer_load_dwordx4 v28, s[24:27], s92 offen offset:1024 sc1 lds
    s_mov_b64 exec, -1
    s_waitcnt vmcnt(22)
    ds_read_b64_tr_b16 v[208:209], v19 offset:0
    ds_read_b64_tr_b16 v[210:211], v19 offset:1024
    ds_read_b64_tr_b16 v[212:213], v20 offset:0
    ds_read_b64_tr_b16 v[214:215], v20 offset:1024
    s_waitcnt lgkmcnt(0)
    s_cmp_ge_u32 s84, 4
    s_cselect_b32 s65, s85, s75
    s_add_u32 s65, s65, 1146880
    s_add_u32 m0, s72, 0
    s_nop 0
    buffer_load_dwordx4 v12, s[28:31], s65 offen offset:0 lds
    buffer_load_dwordx4 v13, s[28:31], s65 offen offset:1024 lds
    s_waitcnt vmcnt(22)
    ds_read_b64_tr_b16 v[200:201], v19 offset:2048
    ds_read_b64_tr_b16 v[202:203], v19 offset:3072
    ds_read_b64_tr_b16 v[204:205], v20 offset:2048
    ds_read_b64_tr_b16 v[206:207], v20 offset:3072
    s_waitcnt lgkmcnt(0)
    s_cmp_ge_u32 s84, 3
    s_cselect_b32 s65, s85, s75
    s_add_u32 s65, s65, 1261568
    s_add_u32 m0, s72, 2048
    s_nop 0
    buffer_load_dwordx4 v12, s[28:31], s65 offen offset:0 lds
    buffer_load_dwordx4 v13, s[28:31], s65 offen offset:1024 lds
    s_waitcnt vmcnt(22)
    ds_read_b64_tr_b16 v[192:193], v17 offset:0
    ds_read_b64_tr_b16 v[194:195], v17 offset:1024
    ds_read_b64_tr_b16 v[196:197], v18 offset:0
    ds_read_b64_tr_b16 v[198:199], v18 offset:1024
    s_waitcnt lgkmcnt(0)
    s_cmp_ge_u32 s84, 2
    s_cselect_b32 s65, s85, s75
    s_add_u32 s65, s65, 1376256
    s_add_u32 m0, s71, 0
    s_nop 0
    buffer_load_dwordx4 v12, s[28:31], s65 offen offset:0 lds
    buffer_load_dwordx4 v13, s[28:31], s65 offen offset:1024 lds
    s_waitcnt vmcnt(22)
    ds_read_b64_tr_b16 v[184:185], v17 offset:2048
    ds_read_b64_tr_b16 v[186:187], v17 offset:3072
    ds_read_b64_tr_b16 v[188:189], v18 offset:2048
    ds_read_b64_tr_b16 v[190:191], v18 offset:3072
    s_waitcnt lgkmcnt(0)
    s_cmp_ge_u32 s84, 1
    s_cselect_b32 s65, s85, s75
    s_add_u32 s65, s65, 1490944
    s_add_u32 m0, s71, 2048
    s_nop 0
    buffer_load_dwordx4 v12, s[28:31], s65 offen offset:0 lds
    buffer_load_dwordx4 v13, s[28:31], s65 offen offset:1024 lds
    s_waitcnt vmcnt(22)
    ds_read_b64_tr_b16 v[176:177], v17 offset:4096
    ds_read_b64_tr_b16 v[178:179], v17 offset:5120
    ds_read_b64_tr_b16 v[180:181], v18 offset:4096
    ds_read_b64_tr_b16 v[182:183], v18 offset:5120
    s_waitcnt lgkmcnt(0)
    s_cmp_ge_u32 s84, 14
    s_cselect_b32 s65, s85, s75
    s_add_u32 s65, s65, 57344
    s_add_u32 m0, s71, 4096
    s_nop 0
    buffer_load_dwordx4 v12, s[28:31], s65 offen offset:0 lds
    buffer_load_dwordx4 v13, s[28:31], s65 offen offset:1024 lds
    s_waitcnt vmcnt(10)
    s_mov_b64 exec, 1
    ds_add_u32 v27, v30 offset:24
    s_mov_b64 exec, -1
    s_waitcnt vmcnt(8)
    ds_read_b64_tr_b16 v[168:169], v19 offset:0
    ds_read_b64_tr_b16 v[170:171], v19 offset:1024
    ds_read_b64_tr_b16 v[172:173], v20 offset:0
    ds_read_b64_tr_b16 v[174:175], v20 offset:1024
    s_waitcnt lgkmcnt(0)
    s_cmp_ge_u32 s84, 13
    s_cselect_b32 s65, s85, s75
    s_add_u32 s65, s65, 172032
    s_add_u32 m0, s72, 0
    s_nop 0
    buffer_load_dwordx4 v12, s[28:31], s65 offen offset:0 lds
    buffer_load_dwordx4 v13, s[28:31], s65 offen offset:1024 lds
    s_waitcnt vmcnt(8)
    ds_read_b64_tr_b16 v[160:161], v19 offset:2048
    ds_read_b64_tr_b16 v[162:163], v19 offset:3072
    ds_read_b64_tr_b16 v[164:165], v20 offset:2048
    ds_read_b64_tr_b16 v[166:167], v20 offset:3072
    s_waitcnt lgkmcnt(0)
    s_cmp_ge_u32 s84, 12
    s_cselect_b32 s65, s85, s75
    s_add_u32 s65, s65, 286720
    s_add_u32 m0, s72, 2048
    s_nop 0
    buffer_load_dwordx4 v12, s[28:31], s65 offen offset:0 lds
    buffer_load_dwordx4 v13, s[28:31], s65 offen offset:1024 lds
    s_mov_b32 s95, 0
LW_34:
    ds_read_b32 v29, v27 offset:40
    s_add_u32 s95, s95, 1
    s_lshr_b32 s94, s95, 18
    s_waitcnt lgkmcnt(0)
    v_readfirstlane_b32 s97, v29
    s_nop 0
    s_add_u32 s97, s97, s94
    s_cmp_ge_u32 s97, 4
    s_cbranch_scc1 LW_34_d
    s_sleep 2
    s_branch LW_34
LW_34_d:
    s_cmp_ge_u32 s84, 11
    s_cselect_b32 s65, s85, s75
    s_add_u32 s65, s65, 401408
    s_add_u32 m0, s73, 0
    s_nop 0
    buffer_load_dwordx4 v12, s[28:31], s65 offen offset:0 lds
    buffer_load_dwordx4 v13, s[28:31], s65 offen offset:1024 lds
    s_cmp_ge_u32 s84, 10
    s_cselect_b32 s65, s85, s75
    s_add_u32 s65, s65, 516096
    s_add_u32 m0, s73, 2048
    s_nop 0
    buffer_load_dwordx4 v12, s[28:31], s65 offen offset:0 lds
    buffer_load_dwordx4 v13, s[28:31], s65 offen offset:1024 lds
    s_cmp_ge_u32 s84, 9
    s_cselect_b32 s65, s85, s75
    s_add_u32 s65, s65, 630784
    s_add_u32 m0, s73, 4096
    s_nop 0
    buffer_load_dwordx4 v12, s[28:31], s65 offen offset:0 lds
    buffer_load_dwordx4 v13, s[28:31], s65 offen offset:1024 lds
    s_cmp_ge_u32 s84, 8
    s_cselect_b32 s65, s85, s75
    s_add_u32 s65, s65, 745472
    s_add_u32 m0, s73, 6144
    s_nop 0
    buffer_load_dwordx4 v12, s[28:31], s65 offen offset:0 lds
    buffer_load_dwordx4 v13, s[28:31], s65 offen offset:1024 lds
    s_cmp_ge_u32 s84, 7
    s_cselect_b32 s65, s85, s75
    s_add_u32 s65, s65, 860160
    s_add_u32 m0, s73, 8192
    s_nop 0
    buffer_load_dwordx4 v12, s[28:31], s65 offen offset:0 lds
    buffer_load_dwordx4 v13, s[28:31], s65 offen offset:1024 lds
    s_cmp_ge_u32 s84, 6
    s_cselect_b32 s65, s85, s75
    s_add_u32 s65, s65, 974848
    s_add_u32 m0, s73, 10240
    s_nop 0
    buffer_load_dwordx4 v12, s[28:31], s65 offen offset:0 lds
    buffer_load_dwordx4 v13, s[28:31], s65 offen offset:1024 lds
    s_cmp_ge_u32 s84, 5
    s_cselect_b32 s65, s85, s75
    s_add_u32 s65, s65, 1089536
    s_add_u32 m0, s73, 12288
    s_nop 0
    buffer_load_dwordx4 v12, s[28:31], s65 offen offset:0 lds
    buffer_load_dwordx4 v13, s[28:31], s65 offen offset:1024 lds
    s_mov_b32 s95, 0
LW_35:
    ds_read_b32 v29, v27 offset:52
    s_add_u32 s95, s95, 1
    s_lshr_b32 s94, s95, 18
    s_waitcnt lgkmcnt(0)
    v_readfirstlane_b32 s97, v29
    s_nop 0
    s_add_u32 s97, s97, s94
    s_cmp_ge_u32 s97, 4
    s_cbranch_scc1 LW_35_d
    s_sleep 2
    s_branch LW_35
LW_35_d:
    buffer_load_dword v5, v4, s[24:27], s79 offen sc1
    s_waitcnt vmcnt(23)
    ds_read_b64_tr_b16 v[152:153], v17 offset:0
    ds_read_b64_tr_b16 v[154:155], v17 offset:1024
    ds_read_b64_tr_b16 v[156:157], v18 offset:0
    ds_read_b64_tr_b16 v[158:159], v18 offset:1024
    s_waitcnt lgkmcnt(0)
    s_cmp_ge_u32 s84, 4
    s_cselect_b32 s65, s85, s75
    s_add_u32 s65, s65, 1204224
    s_add_u32 m0, s71, 0
    s_nop 0
    buffer_load_dwordx4 v12, s[28:31], s65 offen offset:0 lds
    buffer_load_dwordx4 v13, s[28:31], s65 offen offset:1024 lds
    s_waitcnt vmcnt(23)
    ds_read_b64_tr_b16 v[144:145], v17 offset:2048
    ds_read_b64_tr_b16 v[146:147], v17 offset:3072
    ds_read_b64_tr_b16 v[148:149], v18 offset:2048
    ds_read_b64_tr_b16 v[150:151], v18 offset:3072
    s_waitcnt lgkmcnt(0)
    s_cmp_ge_u32 s84, 3
    s_cselect_b32 s65, s85, s75
    s_add_u32 s65, s65, 1318912
    s_add_u32 m0, s71, 2048
    s_nop 0
    buffer_load_dwordx4 v12, s[28:31], s65 offen offset:0 lds
    buffer_load_dwordx4 v13, s[28:31], s65 offen offset:1024 lds
    s_mov_b32 s96, 0
    s_waitcnt vmcnt(4)
    v_cmp_ne_u32 vcc, s55, v5
    s_nop 1
    s_cmp_eq_u64 vcc, 0
    s_cbranch_scc1 GP_36_d
GP_36:
    buffer_load_dword v5, v4, s[24:27], s79 offen sc1
    s_waitcnt vmcnt(0)
    v_cmp_ne_u32 vcc, s55, v5
    s_nop 1
    s_cmp_eq_u64 vcc, 0
    s_cbranch_scc1 GP_36_d
    s_sleep 8
    s_add_u32 s96, s96, 1
    s_cmp_lt_u32 s96, 20000
    s_cbranch_scc1 GP_36
GP_36_d:
    s_cmp_ge_u32 s84, 14
    s_cselect_b32 s65, s86, s77
    s_add_u32 s65, s65, 0
    buffer_load_dwordx4 v[96:99], v22, s[24:27], s65 offen sc1
    buffer_load_dwordx4 v[100:103], v23, s[24:27], s65 offen sc1
    s_cmp_ge_u32 s84, 13
    s_cselect_b32 s65, s86, s77
    s_add_u32 s65, s65, 8192
    buffer_load_dwordx4 v[104:107], v22, s[24:27], s65 offen sc1
    buffer_load_dwordx4 v[108:111], v23, s[24:27], s65 offen sc1
    s_cmp_ge_u32 s84, 12
    s_cselect_b32 s65, s86, s77
    s_add_u32 s65, s65, 16384
    buffer_load_dwordx4 v[112:115], v22, s[24:27], s65 offen sc1
    buffer_load_dwordx4 v[116:119], v23, s[24:27], s65 offen sc1
    s_cmp_ge_u32 s84, 11
    s_cselect_b32 s65, s86, s77
    s_add_u32 s65, s65, 24576
    buffer_load_dwordx4 v[120:123], v22, s[24:27], s65 offen sc1
    buffer_load_dwordx4 v[124:127], v23, s[24:27], s65 offen sc1
    s_cmp_ge_u32 s84, 10
    s_cselect_b32 s65, s86, s77
    s_add_u32 s65, s65, 32768
    buffer_load_dwordx4 v[128:131], v22, s[24:27], s65 offen sc1
    buffer_load_dwordx4 v[132:135], v23, s[24:27], s65 offen sc1
    s_cmp_ge_u32 s84, 9
    s_cselect_b32 s65, s86, s77
    s_add_u32 s65, s65, 40960
    buffer_load_dwordx4 v[136:139], v22, s[24:27], s65 offen sc1
    buffer_load_dwordx4 v[140:143], v23, s[24:27], s65 offen sc1
    s_waitcnt vmcnt(10)
    v_mfma_f32_32x32x16_bf16 v[32:47], v[248:251], v[96:99], v[32:47]
    v_mfma_f32_32x32x16_bf16 v[48:63], v[248:251], v[100:103], v[48:63]
    v_mfma_f32_32x32x16_bf16 v[64:79], v[252:255], v[96:99], v[64:79]
    v_mfma_f32_32x32x16_bf16 v[80:95], v[252:255], v[100:103], v[80:95]
    s_waitcnt vmcnt(8)
    v_mfma_f32_32x32x16_bf16 v[32:47], v[240:243], v[104:107], v[32:47]
    s_cmp_ge_u32 s84, 8
    s_cselect_b32 s65, s86, s77
    s_add_u32 s65, s65, 49152
    buffer_load_dwordx4 v[96:99], v22, s[24:27], s65 offen sc1
    v_mfma_f32_32x32x16_bf16 v[48:63], v[240:243], v[108:111], v[48:63]
    buffer_load_dwordx4 v[100:103], v23, s[24:27], s65 offen sc1
    v_mfma_f32_32x32x16_bf16 v[64:79], v[244:247], v[104:107], v[64:79]
    s_cmp_ge_u32 s84, 7
    s_cselect_b32 s65, s86, s77
    s_add_u32 s65, s65, 57344
    buffer_load_dwordx4 v[248:251], v22, s[24:27], s65 offen sc1
    v_mfma_f32_32x32x16_bf16 v[80:95], v[244:247], v[108:111], v[80:95]
    buffer_load_dwordx4 v[252:255], v23, s[24:27], s65 offen sc1
    buffer_load_dword v5, v4, s[24:27], s80 offen sc1
    s_waitcnt vmcnt(11)
    v_mfma_f32_32x32x16_bf16 v[32:47], v[232:235], v[112:115], v[32:47]
    s_cmp_ge_u32 s84, 6
    s_cselect_b32 s65, s86, s77
    s_add_u32 s65, s65, 65536
    buffer_load_dwordx4 v[104:107], v22, s[24:27], s65 offen sc1
    v_mfma_f32_32x32x16_bf16 v[48:63], v[232:235], v[116:119], v[48:63]
    buffer_load_dwordx4 v[108:111], v23, s[24:27], s65 offen sc1
    v_mfma_f32_32x32x16_bf16 v[64:79], v[236:239], v[112:115], v[64:79]
    s_cmp_ge_u32 s84, 5
    s_cselect_b32 s65, s86, s77
    s_add_u32 s65, s65, 73728
    buffer_load_dwordx4 v[240:243], v22, s[24:27], s65 offen sc1
    v_mfma_f32_32x32x16_bf16 v[80:95], v[236:239], v[116:119], v[80:95]
    buffer_load_dwordx4 v[244:247], v23, s[24:27], s65 offen sc1
    s_waitcnt vmcnt(13)
    v_mfma_f32_32x32x16_bf16 v[32:47], v[224:227], v[120:123], v[32:47]
    s_cmp_ge_u32 s84, 4
    s_cselect_b32 s65, s86, s77
    s_add_u32 s65, s65, 81920
    buffer_load_dwordx4 v[112:115], v22, s[24:27], s65 offen sc1
    v_mfma_f32_32x32x16_bf16 v[48:63], v[224:227], v[124:127], v[48:63]
    buffer_load_dwordx4 v[116:119], v23, s[24:27], s65 offen sc1
    v_mfma_f32_32x32x16_bf16 v[64:79], v[228:231], v[120:123], v[64:79]
    s_cmp_ge_u32 s84, 3
    s_cselect_b32 s65, s86, s77
    s_add_u32 s65, s65, 90112
    buffer_load_dwordx4 v[232:235], v22, s[24:27], s65 offen sc1
    v_mfma_f32_32x32x16_bf16 v[80:95], v[228:231], v[124:127], v[80:95]
    buffer_load_dwordx4 v[236:239], v23, s[24:27], s65 offen sc1
    s_waitcnt vmcnt(15)
    v_mfma_f32_32x32x16_bf16 v[32:47], v[216:219], v[128:131], v[32:47]
    s_cmp_ge_u32 s84, 2
    s_cselect_b32 s65, s86, s77
    s_add_u32 s65, s65, 98304
    buffer_load_dwordx4 v[120:123], v22, s[24:27], s65 offen sc1
    v_mfma_f32_32x32x16_bf16 v[48:63], v[216:219], v[132:135], v[48:63]
    buffer_load_dwordx4 v[124:127], v23, s[24:27], s65 offen sc1
    v_mfma_f32_32x32x16_bf16 v[64:79], v[220:223], v[128:131], v[64:79]
    v_mfma_f32_32x32x16_bf16 v[80:95], v[220:223], v[132:135], v[80:95]
    s_waitcnt vmcnt(15)
    v_mfma_f32_32x32x16_bf16 v[32:47], v[208:211], v[136:139], v[32:47]
    s_cmp_ge_u32 s84, 1
    s_cselect_b32 s65, s86, s77
    s_add_u32 s65, s65, 106496
    buffer_load_dwordx4 v[224:227], v22, s[24:27], s65 offen sc1
    v_mfma_f32_32x32x16_bf16 v[48:63], v[208:211], v[140:143], v[48:63]
    buffer_load_dwordx4 v[228:231], v23, s[24:27], s65 offen sc1
    v_mfma_f32_32x32x16_bf16 v[64:79], v[212:215], v[136:139], v[64:79]
    v_mfma_f32_32x32x16_bf16 v[80:95], v[212:215], v[140:143], v[80:95]
    s_waitcnt vmcnt(15)
    v_mfma_f32_32x32x16_bf16 v[32:47], v[200:203], v[96:99], v[32:47]
    v_mfma_f32_32x32x16_bf16 v[48:63], v[200:203], v[100:103], v[48:63]
    v_mfma_f32_32x32x16_bf16 v[64:79], v[204:207], v[96:99], v[64:79]
    v_mfma_f32_32x32x16_bf16 v[80:95], v[204:207], v[100:103], v[80:95]
    s_waitcnt vmcnt(13)
    v_mfma_f32_32x32x16_bf16 v[32:47], v[192:195], v[248:251], v[32:47]
    v_mfma_f32_32x32x16_bf16 v[48:63], v[192:195], v[252:255], v[48:63]
    v_mfma_f32_32x32x16_bf16 v[64:79], v[196:199], v[248:251], v[64:79]
    v_mfma_f32_32x32x16_bf16 v[80:95], v[196:199], v[252:255], v[80:95]
    s_mov_b32 s96, 0
    s_waitcnt vmcnt(12)
    v_cmp_ne_u32 vcc, s55, v5
    s_nop 1
    s_cmp_eq_u64 vcc, 0
    s_cbranch_scc1 GP_37_d
GP_37:
    buffer_load_dword v5, v4, s[24:27], s80 offen sc1
    s_waitcnt vmcnt(0)
    v_cmp_ne_u32 vcc, s55, v5
    s_nop 1
    s_cmp_eq_u64 vcc, 0
    s_cbranch_scc1 GP_37_d
    s_sleep 8
    s_add_u32 s96, s96, 1
    s_cmp_lt_u32 s96, 20000
    s_cbranch_scc1 GP_37
GP_37_d:
    s_cmp_ge_u32 s84, 14
    s_cselect_b32 s65, s86, s77
    s_add_u32 s65, s65, 4096
    buffer_load_dwordx4 v[128:131], v22, s[24:27], s65 offen sc1
    buffer_load_dwordx4 v[132:135], v23, s[24:27], s65 offen sc1
    s_cmp_ge_u32 s84, 13
    s_cselect_b32 s65, s86, s77
    s_add_u32 s65, s65, 12288
    buffer_load_dwordx4 v[216:219], v22, s[24:27], s65 offen sc1
    buffer_load_dwordx4 v[220:223], v23, s[24:27], s65 offen sc1
    s_cmp_ge_u32 s84, 12
    s_cselect_b32 s65, s86, s77
    s_add_u32 s65, s65, 20480
    buffer_load_dwordx4 v[136:139], v22, s[24:27], s65 offen sc1
    buffer_load_dwordx4 v[140:143], v23, s[24:27], s65 offen sc1
    s_waitcnt vmcnt(16)
    v_mfma_f32_32x32x16_bf16 v[32:47], v[184:187], v[104:107], v[32:47]
    v_mfma_f32_32x32x16_bf16 v[48:63], v[184:187], v[108:111], v[48:63]
    v_mfma_f32_32x32x16_bf16 v[64:79], v[188:191], v[104:107], v[64:79]
    v_mfma_f32_32x32x16_bf16 v[80:95], v[188:191], v[108:111], v[80:95]
    s_waitcnt vmcnt(14)
    v_mfma_f32_32x32x16_bf16 v[32:47], v[176:179], v[240:243], v[32:47]
    s_cmp_ge_u32 s84, 11
    s_cselect_b32 s65, s86, s77
    s_add_u32 s65, s65, 28672
    buffer_load_dwordx4 v[208:211], v22, s[24:27], s65 offen sc1
    v_mfma_f32_32x32x16_bf16 v[48:63], v[176:179], v[244:247], v[48:63]
    buffer_load_dwordx4 v[212:215], v23, s[24:27], s65 offen sc1
    v_mfma_f32_32x32x16_bf16 v[64:79], v[180:183], v[240:243], v[64:79]
    v_mfma_f32_32x32x16_bf16 v[80:95], v[180:183], v[244:247], v[80:95]
    s_waitcnt vmcnt(14)
    v_mfma_f32_32x32x16_bf16 v[32:47], v[168:171], v[112:115], v[32:47]
    s_cmp_ge_u32 s84, 10
    s_cselect_b32 s65, s86, s77
    s_add_u32 s65, s65, 36864
    buffer_load_dwordx4 v[96:99], v22, s[24:27], s65 offen sc1
    v_mfma_f32_32x32x16_bf16 v[48:63], v[168:171], v[116:119], v[48:63]
    buffer_load_dwordx4 v[100:103], v23, s[24:27], s65 offen sc1
    v_mfma_f32_32x32x16_bf16 v[64:79], v[172:175], v[112:115], v[64:79]
    v_mfma_f32_32x32x16_bf16 v[80:95], v[172:175], v[116:119], v[80:95]
    s_waitcnt vmcnt(14)
    v_mfma_f32_32x32x16_bf16 v[32:47], v[160:163], v[232:235], v[32:47]
    s_cmp_ge_u32 s84, 9
    s_cselect_b32 s65, s86, s77
    s_add_u32 s65, s65, 45056
    buffer_load_dwordx4 v[200:203], v22, s[24:27], s65 offen sc1
    v_mfma_f32_32x32x16_bf16 v[48:63], v[160:163], v[236:239], v[48:63]
    buffer_load_dwordx4 v[204:207], v23, s[24:27], s65 offen sc1
    v_mfma_f32_32x32x16_bf16 v[64:79], v[164:167], v[232:235], v[64:79]
    v_mfma_f32_32x32x16_bf16 v[80:95], v[164:167], v[236:239], v[80:95]
    s_waitcnt vmcnt(14)
    v_mfma_f32_32x32x16_bf16 v[32:47], v[152:155], v[120:123], v[32:47]
    s_cmp_ge_u32 s84, 8
    s_cselect_b32 s65, s86, s77
    s_add_u32 s65, s65, 53248
    buffer_load_dwordx4 v[248:251], v22, s[24:27], s65 offen sc1
    v_mfma_f32_32x32x16_bf16 v[48:63], v[152:155], v[124:127], v[48:63]
    buffer_load_dwordx4 v[252:255], v23, s[24:27], s65 offen sc1
    v_mfma_f32_32x32x16_bf16 v[64:79], v[156:159], v[120:123], v[64:79]
    v_mfma_f32_32x32x16_bf16 v[80:95], v[156:159], v[124:127], v[80:95]
    s_waitcnt vmcnt(62)
    ds_read_b64_tr_b16 v[104:105], v17 offset:4096
    ds_read_b64_tr_b16 v[106:107], v17 offset:5120
    ds_read_b64_tr_b16 v[108:109], v18 offset:4096
    ds_read_b64_tr_b16 v[110:111], v18 offset:5120
    s_waitcnt vmcnt(14)
    v_mfma_f32_32x32x16_bf16 v[32:47], v[144:147], v[224:227], v[32:47]
    s_cmp_ge_u32 s84, 7
    s_cselect_b32 s65, s86, s77
    s_add_u32 s65, s65, 61440
    buffer_load_dwordx4 v[192:195], v22, s[24:27], s65 offen sc1
    v_mfma_f32_32x32x16_bf16 v[48:63], v[144:147], v[228:231], v[48:63]
    buffer_load_dwordx4 v[196:199], v23, s[24:27], s65 offen sc1
    v_mfma_f32_32x32x16_bf16 v[64:79], v[148:151], v[224:227], v[64:79]
    v_mfma_f32_32x32x16_bf16 v[80:95], v[148:151], v[228:231], v[80:95]
    s_waitcnt vmcnt(62)
    ds_read_b64_tr_b16 v[240:241], v19 offset:0
    ds_read_b64_tr_b16 v[242:243], v19 offset:1024
    ds_read_b64_tr_b16 v[244:245], v20 offset:0
    ds_read_b64_tr_b16 v[246:247], v20 offset:1024
    s_waitcnt vmcnt(14) lgkmcnt(4)
    v_mfma_f32_32x32x16_bf16 v[32:47], v[104:107], v[128:131], v[32:47]
    s_cmp_ge_u32 s84, 6
    s_cselect_b32 s65, s86, s77
    s_add_u32 s65, s65, 69632
    buffer_load_dwordx4 v[184:187], v22, s[24:27], s65 offen sc1
    v_mfma_f32_32x32x16_bf16 v[48:63], v[104:107], v[132:135], v[48:63]
    buffer_load_dwordx4 v[188:191], v23, s[24:27], s65 offen sc1
    v_mfma_f32_32x32x16_bf16 v[64:79], v[108:111], v[128:131], v[64:79]
    s_cmp_ge_u32 s84, 2
    s_cselect_b32 s65, s85, s75
    s_add_u32 s65, s65, 1433600
    s_add_u32 m0, s71, 4096
    s_nop 0
    buffer_load_dwordx4 v12, s[28:31], s65 offen offset:0 lds
    v_mfma_f32_32x32x16_bf16 v[80:95], v[108:111], v[132:135], v[80:95]
    buffer_load_dwordx4 v13, s[28:31], s65 offen offset:1024 lds
    s_waitcnt vmcnt(62)
    ds_read_b64_tr_b16 v[112:113], v19 offset:2048
    ds_read_b64_tr_b16 v[114:115], v19 offset:3072
    ds_read_b64_tr_b16 v[116:117], v20 offset:2048
    ds_read_b64_tr_b16 v[118:119], v20 offset:3072
    s_waitcnt vmcnt(16) lgkmcnt(4)
    v_mfma_f32_32x32x16_bf16 v[32:47], v[240:243], v[216:219], v[32:47]
    s_cmp_ge_u32 s84, 5
    s_cselect_b32 s65, s86, s77
    s_add_u32 s65, s65, 77824
    buffer_load_dwordx4 v[176:179], v22, s[24:27], s65 offen sc1
    v_mfma_f32_32x32x16_bf16 v[48:63], v[240:243], v[220:223], v[48:63]
    buffer_load_dwordx4 v[180:183], v23, s[24:27], s65 offen sc1
    v_mfma_f32_32x32x16_bf16 v[64:79], v[244:247], v[216:219], v[64:79]
    s_cmp_ge_u32 s84, 1
    s_cselect_b32 s65, s85, s75
    s_add_u32 s65, s65, 1548288
    s_add_u32 m0, s72, 0
    s_nop 0
    buffer_load_dwordx4 v12, s[28:31], s65 offen offset:0 lds
    v_mfma_f32_32x32x16_bf16 v[80:95], v[244:247], v[220:223], v[80:95]
    buffer_load_dwordx4 v13, s[28:31], s65 offen offset:1024 lds
    s_waitcnt vmcnt(62)
    ds_read_b64_tr_b16 v[232:233], v25 offset:0
    ds_read_b64_tr_b16 v[234:235], v25 offset:1024
    ds_read_b64_tr_b16 v[236:237], v26 offset:0
    ds_read_b64_tr_b16 v[238:239], v26 offset:1024
    s_waitcnt vmcnt(18) lgkmcnt(4)
    v_mfma_f32_32x32x16_bf16 v[32:47], v[112:115], v[136:139], v[32:47]
    s_cmp_ge_u32 s84, 4
    s_cselect_b32 s65, s86, s77
    s_add_u32 s65, s65, 86016
    buffer_load_dwordx4 v[168:171], v22, s[24:27], s65 offen sc1
    v_mfma_f32_32x32x16_bf16 v[48:63], v[112:115], v[140:143], v[48:63]
    buffer_load_dwordx4 v[172:175], v23, s[24:27], s65 offen sc1
    v_mfma_f32_32x32x16_bf16 v[64:79], v[116:119], v[136:139], v[64:79]
    s_add_u32 s65, s76, 0
    s_add_u32 m0, s72, 2048
    s_nop 0
    buffer_load_dwordx4 v12, s[32:35], s65 offen offset:0 lds
    v_mfma_f32_32x32x16_bf16 v[80:95], v[116:119], v[140:143], v[80:95]
    buffer_load_dwordx4 v13, s[32:35], s65 offen offset:1024 lds
    s_waitcnt vmcnt(62)
    ds_read_b64_tr_b16 v[120:121], v25 offset:2048
    ds_read_b64_tr_b16 v[122:123], v25 offset:3072
    ds_read_b64_tr_b16 v[124:125], v26 offset:2048
    ds_read_b64_tr_b16 v[126:127], v26 offset:3072
    s_waitcnt vmcnt(20) lgkmcnt(4)
    v_mfma_f32_32x32x16_bf16 v[32:47], v[232:235], v[208:211], v[32:47]
    s_cmp_ge_u32 s84, 3
    s_cselect_b32 s65, s86, s77
    s_add_u32 s65, s65, 94208
    buffer_load_dwordx4 v[160:163], v22, s[24:27], s65 offen sc1
    v_mfma_f32_32x32x16_bf16 v[48:63], v[232:235], v[212:215], v[48:63]
    buffer_load_dwordx4 v[164:167], v23, s[24:27], s65 offen sc1
    v_mfma_f32_32x32x16_bf16 v[64:79], v[236:239], v[208:211], v[64:79]
    s_add_u32 s65, s76, 14336
    s_add_u32 m0, s73, 0
    s_nop 0
    buffer_load_dwordx4 v12, s[32:35], s65 offen offset:0 lds
    v_mfma_f32_32x32x16_bf16 v[80:95], v[236:239], v[212:215], v[80:95]
    buffer_load_dwordx4 v13, s[32:35], s65 offen offset:1024 lds
    s_waitcnt vmcnt(62)
    ds_read_b64_tr_b16 v[224:225], v25 offset:4096
    ds_read_b64_tr_b16 v[226:227], v25 offset:5120
    ds_read_b64_tr_b16 v[228:229], v26 offset:4096
    ds_read_b64_tr_b16 v[230:231], v26 offset:5120
    s_waitcnt vmcnt(22) lgkmcnt(4)
    v_mfma_f32_32x32x16_bf16 v[32:47], v[120:123], v[96:99], v[32:47]
    s_cmp_ge_u32 s84, 2
    s_cselect_b32 s65, s86, s77
    s_add_u32 s65, s65, 102400
    buffer_load_dwordx4 v[152:155], v22, s[24:27], s65 offen sc1
    v_mfma_f32_32x32x16_bf16 v[48:63], v[120:123], v[100:103], v[48:63]
    buffer_load_dwordx4 v[156:159], v23, s[24:27], s65 offen sc1
    v_mfma_f32_32x32x16_bf16 v[64:79], v[124:127], v[96:99], v[64:79]
    s_add_u32 s65, s76, 25088
    s_add_u32 m0, s73, 2048
    s_nop 0
    buffer_load_dwordx4 v12, s[32:35], s65 offen offset:0 lds
    v_mfma_f32_32x32x16_bf16 v[80:95], v[124:127], v[100:103], v[80:95]
    buffer_load_dwordx4 v13, s[32:35], s65 offen offset:1024 lds
    buffer_load_dword v5, v6, s[24:27], s81 offen sc1
    s_waitcnt vmcnt(62)
    ds_read_b64_tr_b16 v[128:129], v25 offset:6144
    ds_read_b64_tr_b16 v[130:131], v25 offset:7168
    ds_read_b64_tr_b16 v[132:133], v26 offset:6144
    ds_read_b64_tr_b16 v[134:135], v26 offset:7168
    s_waitcnt vmcnt(25) lgkmcnt(4)
    v_mfma_f32_32x32x16_bf16 v[32:47], v[224:227], v[200:203], v[32:47]
    s_cmp_ge_u32 s84, 1
    s_cselect_b32 s65, s86, s77
    s_add_u32 s65, s65, 110592
    buffer_load_dwordx4 v[144:147], v22, s[24:27], s65 offen sc1
    v_mfma_f32_32x32x16_bf16 v[48:63], v[224:227], v[204:207], v[48:63]
    buffer_load_dwordx4 v[148:151], v23, s[24:27], s65 offen sc1
    v_mfma_f32_32x32x16_bf16 v[64:79], v[228:231], v[200:203], v[64:79]
    s_add_u32 s65, s76, 39424
    s_add_u32 m0, s73, 4096
    s_nop 0
    buffer_load_dwordx4 v12, s[32:35], s65 offen offset:0 lds
    v_mfma_f32_32x32x16_bf16 v[80:95], v[228:231], v[204:207], v[80:95]
    buffer_load_dwordx4 v13, s[32:35], s65 offen offset:1024 lds
    s_waitcnt vmcnt(62)
    ds_read_b64_tr_b16 v[104:105], v25 offset:8192
    ds_read_b64_tr_b16 v[106:107], v25 offset:9216
    ds_read_b64_tr_b16 v[108:109], v26 offset:8192
    ds_read_b64_tr_b16 v[110:111], v26 offset:9216
    s_waitcnt vmcnt(27) lgkmcnt(4)
    v_mfma_f32_32x32x16_bf16 v[32:47], v[128:131], v[248:251], v[32:47]
    s_add_u32 s65, s76, 50176
    s_add_u32 m0, s73, 6144
    s_nop 0
    buffer_load_dwordx4 v12, s[32:35], s65 offen offset:0 lds
    v_mfma_f32_32x32x16_bf16 v[48:63], v[128:131], v[252:255], v[48:63]
    buffer_load_dwordx4 v13, s[32:35], s65 offen offset:1024 lds
    v_mfma_f32_32x32x16_bf16 v[64:79], v[132:135], v[248:251], v[64:79]
    v_mfma_f32_32x32x16_bf16 v[80:95], v[132:135], v[252:255], v[80:95]
    s_waitcnt vmcnt(62)
    ds_read_b64_tr_b16 v[216:217], v25 offset:10240
    ds_read_b64_tr_b16 v[218:219], v25 offset:11264
    ds_read_b64_tr_b16 v[220:221], v26 offset:10240
    ds_read_b64_tr_b16 v[222:223], v26 offset:11264
    s_waitcnt vmcnt(27) lgkmcnt(4)
    v_mfma_f32_32x32x16_bf16 v[32:47], v[104:107], v[192:195], v[32:47]
    s_add_u32 s65, s76, 64512
    s_add_u32 m0, s73, 8192
    s_nop 0
    buffer_load_dwordx4 v12, s[32:35], s65 offen offset:0 lds
    v_mfma_f32_32x32x16_bf16 v[48:63], v[104:107], v[196:199], v[48:63]
    buffer_load_dwordx4 v13, s[32:35], s65 offen offset:1024 lds
    v_mfma_f32_32x32x16_bf16 v[64:79], v[108:111], v[192:195], v[64:79]
    v_mfma_f32_32x32x16_bf16 v[80:95], v[108:111], v[196:199], v[80:95]
    s_waitcnt vmcnt(62)
    ds_read_b64_tr_b16 v[240:241], v25 offset:12288
    ds_read_b64_tr_b16 v[242:243], v25 offset:13312
    ds_read_b64_tr_b16 v[244:245], v26 offset:12288
    ds_read_b64_tr_b16 v[246:247], v26 offset:13312
    s_waitcnt vmcnt(27) lgkmcnt(4)
    v_mfma_f32_32x32x16_bf16 v[32:47], v[216:219], v[184:187], v[32:47]
    s_add_u32 s65, s76, 75264
    s_add_u32 m0, s73, 10240
    s_nop 0
    buffer_load_dwordx4 v12, s[32:35], s65 offen offset:0 lds
    v_mfma_f32_32x32x16_bf16 v[48:63], v[216:219], v[188:191], v[48:63]
    buffer_load_dwordx4 v13, s[32:35], s65 offen offset:1024 lds
    v_mfma_f32_32x32x16_bf16 v[64:79], v[220:223], v[184:187], v[64:79]
    v_mfma_f32_32x32x16_bf16 v[80:95], v[220:223], v[188:191], v[80:95]
    s_waitcnt vmcnt(62)
    ds_read_b64_tr_b16 v[136:137], v17 offset:0
    ds_read_b64_tr_b16 v[138:139], v17 offset:1024
    ds_read_b64_tr_b16 v[140:141], v18 offset:0
    ds_read_b64_tr_b16 v[142:143], v18 offset:1024
    s_waitcnt vmcnt(25) lgkmcnt(4)
    v_mfma_f32_32x32x16_bf16 v[32:47], v[240:243], v[176:179], v[32:47]
    s_add_u32 s65, s76, 89600
    s_add_u32 m0, s73, 12288
    s_nop 0
    buffer_load_dwordx4 v12, s[32:35], s65 offen offset:0 lds
    v_mfma_f32_32x32x16_bf16 v[48:63], v[240:243], v[180:183], v[48:63]
    buffer_load_dwordx4 v13, s[32:35], s65 offen offset:1024 lds
    v_mfma_f32_32x32x16_bf16 v[64:79], v[244:247], v[176:179], v[64:79]
    v_mfma_f32_32x32x16_bf16 v[80:95], v[244:247], v[180:183], v[80:95]
    s_waitcnt vmcnt(62)
    ds_read_b64_tr_b16 v[112:113], v17 offset:2048
    ds_read_b64_tr_b16 v[114:115], v17 offset:3072
    ds_read_b64_tr_b16 v[116:117], v18 offset:2048
    ds_read_b64_tr_b16 v[118:119], v18 offset:3072
    s_waitcnt vmcnt(23) lgkmcnt(4)
    v_mfma_f32_32x32x16_bf16 v[32:47], v[136:139], v[168:171], v[32:47]
    v_mfma_f32_32x32x16_bf16 v[48:63], v[136:139], v[172:175], v[48:63]
    v_mfma_f32_32x32x16_bf16 v[64:79], v[140:143], v[168:171], v[64:79]
    v_mfma_f32_32x32x16_bf16 v[80:95], v[140:143], v[172:175], v[80:95]
    s_mov_b32 s96, 0
    s_waitcnt vmcnt(12)
    v_cmp_ne_u32 vcc, s55, v5
    s_nop 1
    s_cmp_eq_u64 vcc, 0
    s_cbranch_scc1 GP_38_d
GP_38:
    buffer_load_dword v5, v6, s[24:27], s81 offen sc1
    s_waitcnt vmcnt(0)
    v_cmp_ne_u32 vcc, s55, v5
    s_nop 1
    s_cmp_eq_u64 vcc, 0
    s_cbranch_scc1 GP_38_d
    s_sleep 8
    s_add_u32 s96, s96, 1
    s_cmp_lt_u32 s96, 20000
    s_cbranch_scc1 GP_38
GP_38_d:
    s_waitcnt vmcnt(29)
    ds_read_b64_tr_b16 v[248:249], v17 offset:4096
    ds_read_b64_tr_b16 v[250:251], v17 offset:5120
    ds_read_b64_tr_b16 v[252:253], v18 offset:4096
    ds_read_b64_tr_b16 v[254:255], v18 offset:5120
    s_add_u32 s65, s78, 0
    buffer_load_dwordx4 v[208:211], v22, s[24:27], s65 offen sc1
    buffer_load_dwordx4 v[212:215], v16, s[24:27], s65 offen sc1
    s_add_u32 s65, s78, 1024
    buffer_load_dwordx4 v[232:235], v22, s[24:27], s65 offen sc1
    buffer_load_dwordx4 v[236:239], v16, s[24:27], s65 offen sc1
    s_add_u32 s65, s78, 2048
    buffer_load_dwordx4 v[96:99], v22, s[24:27], s65 offen sc1
    buffer_load_dwordx4 v[100:103], v16, s[24:27], s65 offen sc1
    s_add_u32 s65, s78, 3072
    buffer_load_dwordx4 v[120:123], v22, s[24:27], s65 offen sc1
    buffer_load_dwordx4 v[124:127], v16, s[24:27], s65 offen sc1
    s_add_u32 s65, s78, 4096
    buffer_load_dwordx4 v[200:203], v22, s[24:27], s65 offen sc1
    buffer_load_dwordx4 v[204:207], v16, s[24:27], s65 offen sc1
    s_add_u32 s65, s78, 5120
    buffer_load_dwordx4 v[224:227], v22, s[24:27], s65 offen sc1
    buffer_load_dwordx4 v[228:231], v16, s[24:27], s65 offen sc1
    s_waitcnt vmcnt(31) lgkmcnt(4)
    v_mfma_f32_32x32x16_bf16 v[32:47], v[112:115], v[160:163], v[32:47]
    v_mfma_f32_32x32x16_bf16 v[48:63], v[112:115], v[164:167], v[48:63]
    v_mfma_f32_32x32x16_bf16 v[64:79], v[116:119], v[160:163], v[64:79]
    v_mfma_f32_32x32x16_bf16 v[80:95], v[116:119], v[164:167], v[80:95]
    s_waitcnt vmcnt(37)
    ds_read_b64_tr_b16 v[192:193], v19 offset:0
    ds_read_b64_tr_b16 v[194:195], v19 offset:1024
    ds_read_b64_tr_b16 v[196:197], v20 offset:0
    ds_read_b64_tr_b16 v[198:199], v20 offset:1024
    s_waitcnt vmcnt(27) lgkmcnt(4)
    v_mfma_f32_32x32x16_bf16 v[32:47], v[248:251], v[152:155], v[32:47]
    s_add_u32 s65, s78, 6144
    buffer_load_dwordx4 v[128:131], v22, s[24:27], s65 offen sc1
    v_mfma_f32_32x32x16_bf16 v[48:63], v[248:251], v[156:159], v[48:63]
    buffer_load_dwordx4 v[132:135], v16, s[24:27], s65 offen sc1
    v_mfma_f32_32x32x16_bf16 v[64:79], v[252:255], v[152:155], v[64:79]
    v_mfma_f32_32x32x16_bf16 v[80:95], v[252:255], v[156:159], v[80:95]
    s_waitcnt vmcnt(35)
    ds_read_b64_tr_b16 v[184:185], v19 offset:2048
    ds_read_b64_tr_b16 v[186:187], v19 offset:3072
    ds_read_b64_tr_b16 v[188:189], v20 offset:2048
    ds_read_b64_tr_b16 v[190:191], v20 offset:3072
    s_waitcnt vmcnt(24) lgkmcnt(4)
    v_mfma_f32_32x32x16_bf16 v[32:47], v[192:195], v[144:147], v[32:47]
    s_add_u32 s65, s78, 7168
    buffer_load_dwordx4 v[104:107], v22, s[24:27], s65 offen sc1
    v_mfma_f32_32x32x16_bf16 v[48:63], v[192:195], v[148:151], v[48:63]
    buffer_load_dwordx4 v[108:111], v16, s[24:27], s65 offen sc1
    v_mfma_f32_32x32x16_bf16 v[64:79], v[196:199], v[144:147], v[64:79]
    v_mfma_f32_32x32x16_bf16 v[80:95], v[196:199], v[148:151], v[80:95]
    s_waitcnt vmcnt(33)
    ds_read_b64_tr_b16 v[216:217], v25 offset:0
    ds_read_b64_tr_b16 v[218:219], v25 offset:1024
    ds_read_b64_tr_b16 v[220:221], v26 offset:0
    ds_read_b64_tr_b16 v[222:223], v26 offset:1024
    s_waitcnt vmcnt(14) lgkmcnt(4)
    v_mfma_f32_32x32x16_bf16 v[32:47], v[184:187], v[208:211], v[32:47]
    v_mfma_f32_32x32x16_bf16 v[48:63], v[184:187], v[212:215], v[48:63]
    v_mfma_f32_32x32x16_bf16 v[64:79], v[188:191], v[208:211], v[64:79]
    v_mfma_f32_32x32x16_bf16 v[80:95], v[188:191], v[212:215], v[80:95]
    s_waitcnt vmcnt(29)
    ds_read_b64_tr_b16 v[176:177], v25 offset:2048
    ds_read_b64_tr_b16 v[178:179], v25 offset:3072
    ds_read_b64_tr_b16 v[180:181], v26 offset:2048
    ds_read_b64_tr_b16 v[182:183], v26 offset:3072
    s_waitcnt vmcnt(12) lgkmcnt(4)
    v_mfma_f32_32x32x16_bf16 v[32:47], v[216:219], v[232:235], v[32:47]
    v_mfma_f32_32x32x16_bf16 v[48:63], v[216:219], v[236:239], v[48:63]
    v_mfma_f32_32x32x16_bf16 v[64:79], v[220:223], v[232:235], v[64:79]
    v_mfma_f32_32x32x16_bf16 v[80:95], v[220:223], v[236:239], v[80:95]
    s_waitcnt vmcnt(24)
    ds_read_b64_tr_b16 v[240:241], v25 offset:4096
    ds_read_b64_tr_b16 v[242:243], v25 offset:5120
    ds_read_b64_tr_b16 v[244:245], v26 offset:4096
    ds_read_b64_tr_b16 v[246:247], v26 offset:5120
    s_waitcnt vmcnt(10) lgkmcnt(4)
    ds_read_b32 v29, v27 offset:60
    v_mfma_f32_32x32x16_bf16 v[32:47], v[176:179], v[96:99], v[32:47]
    v_mfma_f32_32x32x16_bf16 v[48:63], v[176:179], v[100:103], v[48:63]
    v_mfma_f32_32x32x16_bf16 v[64:79], v[180:183], v[96:99], v[64:79]
    v_mfma_f32_32x32x16_bf16 v[80:95], v[180:183], v[100:103], v[80:95]
    s_waitcnt vmcnt(22)
    ds_read_b64_tr_b16 v[168:169], v25 offset:6144
    ds_read_b64_tr_b16 v[170:171], v25 offset:7168
    ds_read_b64_tr_b16 v[172:173], v26 offset:6144
    ds_read_b64_tr_b16 v[174:175], v26 offset:7168
    s_waitcnt vmcnt(8) lgkmcnt(5)
    v_mfma_f32_32x32x16_bf16 v[32:47], v[240:243], v[120:123], v[32:47]
    v_mfma_f32_32x32x16_bf16 v[48:63], v[240:243], v[124:127], v[48:63]
    v_mfma_f32_32x32x16_bf16 v[64:79], v[244:247], v[120:123], v[64:79]
    v_mfma_f32_32x32x16_bf16 v[80:95], v[244:247], v[124:127], v[80:95]
    s_waitcnt vmcnt(20)
    ds_read_b64_tr_b16 v[136:137], v25 offset:8192
    ds_read_b64_tr_b16 v[138:139], v25 offset:9216
    ds_read_b64_tr_b16 v[140:141], v26 offset:8192
    ds_read_b64_tr_b16 v[142:143], v26 offset:9216
    s_waitcnt vmcnt(6) lgkmcnt(4)
    v_mfma_f32_32x32x16_bf16 v[32:47], v[168:171], v[200:203], v[32:47]
    v_mfma_f32_32x32x16_bf16 v[48:63], v[168:171], v[204:207], v[48:63]
    v_mfma_f32_32x32x16_bf16 v[64:79], v[172:175], v[200:203], v[64:79]
    v_mfma_f32_32x32x16_bf16 v[80:95], v[172:175], v[204:207], v[80:95]
    s_waitcnt vmcnt(18)
    ds_read_b64_tr_b16 v[160:161], v25 offset:10240
    ds_read_b64_tr_b16 v[162:163], v25 offset:11264
    ds_read_b64_tr_b16 v[164:165], v26 offset:10240
    ds_read_b64_tr_b16 v[166:167], v26 offset:11264
    s_waitcnt vmcnt(4) lgkmcnt(4)
    v_mfma_f32_32x32x16_bf16 v[32:47], v[136:139], v[224:227], v[32:47]
    v_mfma_f32_32x32x16_bf16 v[48:63], v[136:139], v[228:231], v[48:63]
    v_mfma_f32_32x32x16_bf16 v[64:79], v[140:143], v[224:227], v[64:79]
    v_mfma_f32_32x32x16_bf16 v[80:95], v[140:143], v[228:231], v[80:95]
    s_waitcnt vmcnt(16)
    ds_read_b64_tr_b16 v[112:113], v25 offset:12288
    ds_read_b64_tr_b16 v[114:115], v25 offset:13312
    ds_read_b64_tr_b16 v[116:117], v26 offset:12288
    ds_read_b64_tr_b16 v[118:119], v26 offset:13312
    s_waitcnt vmcnt(2) lgkmcnt(4)
    v_mfma_f32_32x32x16_bf16 v[32:47], v[160:163], v[128:131], v[32:47]
    v_mfma_f32_32x32x16_bf16 v[48:63], v[160:163], v[132:135], v[48:63]
    v_mfma_f32_32x32x16_bf16 v[64:79], v[164:167], v[128:131], v[64:79]
    v_mfma_f32_32x32x16_bf16 v[80:95], v[164:167], v[132:135], v[80:95]
    s_waitcnt vmcnt(0) lgkmcnt(0)
    v_mfma_f32_32x32x16_bf16 v[32:47], v[112:115], v[104:107], v[32:47]
    v_mfma_f32_32x32x16_bf16 v[48:63], v[112:115], v[108:111], v[48:63]
    v_mfma_f32_32x32x16_bf16 v[64:79], v[116:119], v[104:107], v[64:79]
    v_mfma_f32_32x32x16_bf16 v[80:95], v[116:119], v[108:111], v[80:95]
    s_nop 9
    v_readfirstlane_b32 s97, v29
    s_nop 0
    s_cmp_ge_u32 s97, 4
    s_cbranch_scc1 B_rok
    s_mov_b32 s95, 0
LW_39:
    ds_read_b32 v29, v27 offset:60
    s_add_u32 s95, s95, 1
    s_lshr_b32 s94, s95, 18
    s_waitcnt lgkmcnt(0)
    v_readfirstlane_b32 s97, v29
    s_nop 0
    s_add_u32 s97, s97, s94
    s_cmp_ge_u32 s97, 4
    s_cbranch_scc1 LW_39_d
    s_sleep 2
    s_branch LW_39
LW_39_d:
B_rok:
    s_cmp_lg_u32 s48, 0
    s_cbranch_scc1 B_w1
    ds_write_b128 v22, v[48:51] offset:12288
    ds_write_b128 v22, v[52:55] offset:13312
    ds_write_b128 v22, v[56:59] offset:14336
    ds_write_b128 v22, v[60:63] offset:15360
    ds_write_b128 v22, v[64:67] offset:24576
    ds_write_b128 v22, v[68:71] offset:25600
    ds_write_b128 v22, v[72:75] offset:26624
    ds_write_b128 v22, v[76:79] offset:27648
    ds_write_b128 v22, v[80:83] offset:36864
    ds_write_b128 v22, v[84:87] offset:37888
    ds_write_b128 v22, v[88:91] offset:38912
    ds_write_b128 v22, v[92:95] offset:39936
    v_mov_b64 v[144:145], v[32:33]
    v_mov_b64 v[146:147], v[34:35]
    v_mov_b64 v[148:149], v[36:37]
    v_mov_b64 v[150:151], v[38:39]
    v_mov_b64 v[152:153], v[40:41]
    v_mov_b64 v[154:155], v[42:43]
    v_mov_b64 v[156:157], v[44:45]
    v_mov_b64 v[158:159], v[46:47]
    s_branch B_wj
B_w1:
    s_cmp_lg_u32 s48, 1
    s_cbranch_scc1 B_w2
    ds_write_b128 v22, v[32:35] offset:0
    ds_write_b128 v22, v[36:39] offset:1024
    ds_write_b128 v22, v[40:43] offset:2048
    ds_write_b128 v22, v[44:47] offset:3072
    ds_write_b128 v22, v[64:67] offset:28672
    ds_write_b128 v22, v[68:71] offset:29696
    ds_write_b128 v22, v[72:75] offset:30720
    ds_write_b128 v22, v[76:79] offset:31744
    ds_write_b128 v22, v[80:83] offset:40960
    ds_write_b128 v22, v[84:87] offset:41984
    ds_write_b128 v22, v[88:91] offset:43008
    ds_write_b128 v22, v[92:95] offset:44032
    v_mov_b64 v[144:145], v[48:49]
    v_mov_b64 v[146:147], v[50:51]
    v_mov_b64 v[148:149], v[52:53]
    v_mov_b64 v[150:151], v[54:55]
    v_mov_b64 v[152:153], v[56:57]
    v_mov_b64 v[154:155], v[58:59]
    v_mov_b64 v[156:157], v[60:61]
    v_mov_b64 v[158:159], v[62:63]
    s_branch B_wj
B_w2:
    s_cmp_lg_u32 s48, 2
    s_cbranch_scc1 B_w3
    ds_write_b128 v22, v[32:35] offset:4096
    ds_write_b128 v22, v[36:39] offset:5120
    ds_write_b128 v22, v[40:43] offset:6144
    ds_write_b128 v22, v[44:47] offset:7168
    ds_write_b128 v22, v[48:51] offset:16384
    ds_write_b128 v22, v[52:55] offset:17408
    ds_write_b128 v22, v[56:59] offset:18432
    ds_write_b128 v22, v[60:63] offset:19456
    ds_write_b128 v22, v[80:83] offset:45056
    ds_write_b128 v22, v[84:87] offset:46080
    ds_write_b128 v22, v[88:91] offset:47104
    ds_write_b128 v22, v[92:95] offset:48128
    v_mov_b64 v[144:145], v[64:65]
    v_mov_b64 v[146:147], v[66:67]
    v_mov_b64 v[148:149], v[68:69]
    v_mov_b64 v[150:151], v[70:71]
    v_mov_b64 v[152:153], v[72:73]
    v_mov_b64 v[154:155], v[74:75]
    v_mov_b64 v[156:157], v[76:77]
    v_mov_b64 v[158:159], v[78:79]
    s_branch B_wj
B_w3:
    ds_write_b128 v22, v[32:35] offset:8192
    ds_write_b128 v22, v[36:39] offset:9216
    ds_write_b128 v22, v[40:43] offset:10240
    ds_write_b128 v22, v[44:47] offset:11264
    ds_write_b128 v22, v[48:51] offset:20480
    ds_write_b128 v22, v[52:55] offset:21504
    ds_write_b128 v22, v[56:59] offset:22528
    ds_write_b128 v22, v[60:63] offset:23552
    ds_write_b128 v22, v[64:67] offset:32768
    ds_write_b128 v22, v[68:71] offset:33792
    ds_write_b128 v22, v[72:75] offset:34816
    ds_write_b128 v22, v[76:79] offset:35840
    v_mov_b64 v[144:145], v[80:81]
    v_mov_b64 v[146:147], v[82:83]
    v_mov_b64 v[148:149], v[84:85]
    v_mov_b64 v[150:151], v[86:87]
    v_mov_b64 v[152:153], v[88:89]
    v_mov_b64 v[154:155], v[90:91]
    v_mov_b64 v[156:157], v[92:93]
    v_mov_b64 v[158:159], v[94:95]
B_wj:
    s_mul_i32 s65, s48, 12288
    v_add_u32 v10, s65, v22
    s_waitcnt lgkmcnt(0)
    s_barrier
    ds_read_b128 v[96:99], v10 offset:0
    ds_read_b128 v[112:115], v10 offset:4096
    ds_read_b128 v[128:131], v10 offset:8192
    ds_read_b128 v[100:103], v10 offset:1024
    ds_read_b128 v[116:119], v10 offset:5120
    ds_read_b128 v[132:135], v10 offset:9216
    ds_read_b128 v[104:107], v10 offset:2048
    ds_read_b128 v[120:123], v10 offset:6144
    ds_read_b128 v[136:139], v10 offset:10240
    ds_read_b128 v[108:111], v10 offset:3072
    ds_read_b128 v[124:127], v10 offset:7168
    ds_read_b128 v[140:143], v10 offset:11264
    s_waitcnt lgkmcnt(6)
    v_pk_add_f32 v[96:97], v[96:97], v[112:113]
    v_pk_add_f32 v[98:99], v[98:99], v[114:115]
    v_pk_add_f32 v[100:101], v[100:101], v[116:117]
    v_pk_add_f32 v[102:103], v[102:103], v[118:119]
    v_pk_add_f32 v[144:145], v[144:145], v[128:129]
    v_pk_add_f32 v[146:147], v[146:147], v[130:131]
    v_pk_add_f32 v[148:149], v[148:149], v[132:133]
    v_pk_add_f32 v[150:151], v[150:151], v[134:135]
    v_pk_add_f32 v[144:145], v[144:145], v[96:97]
    v_pk_add_f32 v[146:147], v[146:147], v[98:99]
    v_pk_add_f32 v[148:149], v[148:149], v[100:101]
    v_pk_add_f32 v[150:151], v[150:151], v[102:103]
    s_nop 0
    v_permlane32_swap_b32 v144, v148
    v_permlane32_swap_b32 v145, v149
    v_permlane32_swap_b32 v146, v150
    v_permlane32_swap_b32 v147, v151
    v_cvt_pk_bf16_f32 v144, v144, v145
    v_cvt_pk_bf16_f32 v145, v146, v147
    v_cvt_pk_bf16_f32 v146, v148, v149
    v_cvt_pk_bf16_f32 v147, v150, v151
    buffer_store_dwordx4 v[144:147], v14, s[40:43], s45 offen offset:0
    s_waitcnt lgkmcnt(0)
    v_pk_add_f32 v[104:105], v[104:105], v[120:121]
    v_pk_add_f32 v[106:107], v[106:107], v[122:123]
    v_pk_add_f32 v[108:109], v[108:109], v[124:125]
    v_pk_add_f32 v[110:111], v[110:111], v[126:127]
    v_pk_add_f32 v[152:153], v[152:153], v[136:137]
    v_pk_add_f32 v[154:155], v[154:155], v[138:139]
    v_pk_add_f32 v[156:157], v[156:157], v[140:141]
    v_pk_add_f32 v[158:159], v[158:159], v[142:143]
    v_pk_add_f32 v[152:153], v[152:153], v[104:105]
    v_pk_add_f32 v[154:155], v[154:155], v[106:107]
    v_pk_add_f32 v[156:157], v[156:157], v[108:109]
    v_pk_add_f32 v[158:159], v[158:159], v[110:111]
    s_nop 0
    v_permlane32_swap_b32 v152, v156
    v_permlane32_swap_b32 v153, v157
    v_permlane32_swap_b32 v154, v158
    v_permlane32_swap_b32 v155, v159
    v_cvt_pk_bf16_f32 v152, v152, v153
    v_cvt_pk_bf16_f32 v153, v154, v155
    v_cvt_pk_bf16_f32 v154, v156, v157
    v_cvt_pk_bf16_f32 v155, v158, v159
    buffer_store_dwordx4 v[152:155], v14, s[40:43], s45 offen offset:32
    s_endpgm
B_helper:
    s_sub_u32 s64, s56, 28
    s_lshl_b32 s64, s64, 3
    s_and_b32 s65, s2, 7
    s_add_u32 s64, s64, s65
    s_lshl_b32 s64, s64, 2
    s_add_u32 s64, s64, s48
    v_lshlrev_b32 v2, 7, v1
    s_lshl_b32 s64, s64, 13
    s_add_u32 s65, s64, 0x100000
    buffer_load_dword v44, v2, s[12:15], s64 offen
    buffer_load_dword v45, v2, s[12:15], s65 offen
    s_waitcnt vmcnt(0)
    buffer_load_dword v42, v2, s[16:19], s64 offen
    buffer_load_dword v43, v2, s[16:19], s65 offen
    s_waitcnt vmcnt(0)
    buffer_load_dword v46, v2, s[28:31], s64 offen
    buffer_load_dword v47, v2, s[28:31], s65 offen
    buffer_load_dword v48, v2, s[32:35], s64 offen
    s_lshl_b32 s88, s52, 2
    s_mul_i32 s89, s48, 3
    s_add_u32 s89, s89, s88
    s_mul_i32 s90, s48, 6144
    v_and_b32 v2, 31, v1
    v_lshl_add_u32 v2, v2, 3, s90
    v_mov_b32 v9, 0
    s_add_u32 s65, s89, 0
    s_cmp_lt_u32 s65, 8
    s_cselect_b32 s65, 0xf149, 0
    v_mov_b32 v8, s65
    ds_write_b64 v2, v[8:9] offset:1792
    s_add_u32 s65, s89, 1
    s_cmp_lt_u32 s65, 8
    s_cselect_b32 s65, 0xf149, 0
    v_mov_b32 v8, s65
    ds_write_b64 v2, v[8:9] offset:3840
    s_add_u32 s65, s89, 2
    s_cmp_lt_u32 s65, 8
    s_cselect_b32 s65, 0xf149, 0
    v_mov_b32 v8, s65
    ds_write_b64 v2, v[8:9] offset:5888
    v_and_b32 v2, 31, v1
    v_lshl_add_u32 v2, v2, 3, s70
    v_mov_b32 v8, 0x3f80
    ds_write_b64 v2, v[8:9] offset:50944
    v_and_b32 v2, 3, v1
    v_cmp_eq_u32 vcc, 0, v2
    v_mov_b32 v3, 0x3f803f80
    s_nop 0
    v_cndmask_b32 v8, 0, v3, vcc
    v_mov_b32 v9, v8
    v_mov_b32 v10, v8
    v_mov_b32 v11, v8
    v_lshrrev_b32 v3, 2, v1
    v_lshlrev_b32 v3, 9, v3
    v_lshl_add_u32 v3, v2, 4, v3
    v_add_u32 v3, s90, v3
    s_mov_b32 exec_hi, 0xffff
    ds_write_b128 v3, v[8:11] offset:25024
    s_mov_b64 exec, -1
    s_mov_b32 s96, 0
GP_40:
    buffer_load_dword v5, v7, s[24:27], s82 offen sc1
    s_waitcnt vmcnt(0)
    v_cmp_ne_u32 vcc, s55, v5
    s_nop 1
    s_cmp_eq_u64 vcc, 0
    s_cbranch_scc1 GP_40_d
    s_sleep 32
    s_add_u32 s96, s96, 1
    s_cmp_lt_u32 s96, 20000
    s_cbranch_scc1 GP_40
GP_40_d:
    s_mul_i32 s91, s51, 1792
    s_add_u32 s65, s88, s48
    s_mul_i32 s65, s65, 57344
    s_add_u32 s65, s65, s91
    s_add_u32 m0, s70, 49152
    s_nop 0
    buffer_load_dwordx4 v22, s[24:27], s65 offen sc1 lds
    s_mov_b32 exec_hi, 0xffff
    buffer_load_dwordx4 v22, s[24:27], s65 offen offset:1024 sc1 lds
    s_mov_b64 exec, -1
    s_add_u32 s92, s89, 0
    s_sub_u32 s93, s92, 8
    s_mul_i32 s65, s93, 57344
    s_add_u32 s65, s65, s91
    s_add_u32 s65, s65, 28672
    s_mul_i32 s93, s93, 28672
    s_mul_i32 s96, s51, 448
    s_add_u32 s93, s93, s96
    s_add_u32 s93, s93, 4194304
    s_cmp_lt_u32 s92, 8
    s_cselect_b32 s65, 0x7fff0000, s65
    s_cselect_b32 s93, 0x7fff0000, s93
    s_add_u32 s92, s93, 13312
    s_add_u32 m0, s90, 0
    s_nop 0
    buffer_load_dwordx4 v22, s[24:27], s65 offen sc1 lds
    s_mov_b32 exec_hi, 0xffff
    buffer_load_dwordx4 v22, s[24:27], s65 offen offset:1024 sc1 lds
    s_mov_b32 exec_lo, 0x0fffffff
    s_mov_b32 exec_hi, 0x0fffffff
    s_add_u32 m0, s90, 24576
    s_nop 0
    buffer_load_dwordx4 v28, s[24:27], s93 offen sc1 lds
    buffer_load_dwordx4 v28, s[24:27], s92 offen offset:1024 sc1 lds
    s_mov_b64 exec, -1
    s_add_u32 s92, s89, 1
    s_sub_u32 s93, s92, 8
    s_mul_i32 s65, s93, 57344
    s_add_u32 s65, s65, s91
    s_add_u32 s65, s65, 28672
    s_mul_i32 s93, s93, 28672
    s_mul_i32 s96, s51, 448
    s_add_u32 s93, s93, s96
    s_add_u32 s93, s93, 4194304
    s_cmp_lt_u32 s92, 8
    s_cselect_b32 s65, 0x7fff0000, s65
    s_cselect_b32 s93, 0x7fff0000, s93
    s_add_u32 s92, s93, 13312
    s_add_u32 m0, s90, 2048
    s_nop 0
    buffer_load_dwordx4 v22, s[24:27], s65 offen sc1 lds
    s_mov_b32 exec_hi, 0xffff
    buffer_load_dwordx4 v22, s[24:27], s65 offen offset:1024 sc1 lds
    s_mov_b32 exec_lo, 0x0fffffff
    s_mov_b32 exec_hi, 0x0fffffff
    s_add_u32 m0, s90, 26624
    s_nop 0
    buffer_load_dwordx4 v28, s[24:27], s93 offen sc1 lds
    buffer_load_dwordx4 v28, s[24:27], s92 offen offset:1024 sc1 lds
    s_mov_b64 exec, -1
    s_add_u32 s92, s89, 2
    s_sub_u32 s93, s92, 8
    s_mul_i32 s65, s93, 57344
    s_add_u32 s65, s65, s91
    s_add_u32 s65, s65, 28672
    s_mul_i32 s93, s93, 28672
    s_mul_i32 s96, s51, 448
    s_add_u32 s93, s93, s96
    s_add_u32 s93, s93, 4194304
    s_cmp_lt_u32 s92, 8
    s_cselect_b32 s65, 0x7fff0000, s65
    s_cselect_b32 s93, 0x7fff0000, s93
    s_add_u32 s92, s93, 13312
    s_add_u32 m0, s90, 4096
    s_nop 0
    buffer_load_dwordx4 v22, s[24:27], s65 offen sc1 lds
    s_mov_b32 exec_hi, 0xffff
    buffer_load_dwordx4 v22, s[24:27], s65 offen offset:1024 sc1 lds
    s_mov_b32 exec_lo, 0x0fffffff
    s_mov_b32 exec_hi, 0x0fffffff
    s_add_u32 m0, s90, 28672
    s_nop 0
    buffer_load_dwordx4 v28, s[24:27], s93 offen sc1 lds
    buffer_load_dwordx4 v28, s[24:27], s92 offen offset:1024 sc1 lds
    s_mov_b64 exec, -1
    s_waitcnt vmcnt(0)
    s_mov_b64 exec, 1
    ds_add_u32 v27, v30 offset:24
    s_mov_b64 exec, -1
    s_cmp_lg_u32 s2, 255
    s_cbranch_scc1 B_hend
    s_cmp_lg_u32 s48, 0
    s_cbranch_scc1 B_hend
    s_mov_b64 exec, -1
    v_lshlrev_b32 v7, 7, v1
    s_mov_b32 s82, 16908288
    s_mov_b32 s96, 0
GP_41:
    buffer_load_dword v5, v7, s[24:27], s82 offen sc1
    s_waitcnt vmcnt(0)
    v_cmp_ne_u32 vcc, s55, v5
    s_nop 1
    s_cmp_eq_u64 vcc, 0
    s_cbranch_scc1 GP_41_d
    s_sleep 16
    s_add_u32 s96, s96, 1
    s_cmp_lt_u32 s96, 20000
    s_cbranch_scc1 GP_41
GP_41_d:
    s_mov_b32 s82, 16916480
    s_mov_b32 s96, 0
GP_42:
    buffer_load_dword v5, v7, s[24:27], s82 offen sc1
    s_waitcnt vmcnt(0)
    v_cmp_ne_u32 vcc, s55, v5
    s_nop 1
    s_cmp_eq_u64 vcc, 0
    s_cbranch_scc1 GP_42_d
    s_sleep 16
    s_add_u32 s96, s96, 1
    s_cmp_lt_u32 s96, 20000
    s_cbranch_scc1 GP_42
GP_42_d:
    s_mov_b32 s82, 16924672
    s_mov_b32 s96, 0
GP_43:
    buffer_load_dword v5, v7, s[24:27], s82 offen sc1
    s_waitcnt vmcnt(0)
    v_cmp_ne_u32 vcc, s55, v5
    s_nop 1
    s_cmp_eq_u64 vcc, 0
    s_cbranch_scc1 GP_43_d
    s_sleep 16
    s_add_u32 s96, s96, 1
    s_cmp_lt_u32 s96, 20000
    s_cbranch_scc1 GP_43
GP_43_d:
    s_mov_b32 s82, 16932864
    s_mov_b32 s96, 0
GP_44:
    buffer_load_dword v5, v7, s[24:27], s82 offen sc1
    s_waitcnt vmcnt(0)
    v_cmp_ne_u32 vcc, s55, v5
    s_nop 1
    s_cmp_eq_u64 vcc, 0
    s_cbranch_scc1 GP_44_d
    s_sleep 16
    s_add_u32 s96, s96, 1
    s_cmp_lt_u32 s96, 20000
    s_cbranch_scc1 GP_44
GP_44_d:
    v_mov_b32 v2, s55
    v_mov_b32 v3, 0
    s_mov_b32 s65, 16777216
    s_mov_b64 exec, 1
    buffer_store_dword v2, v3, s[24:27], s65 offen sc1
B_hend:
    s_endpgm
K_exit:
    s_endpgm
K_end:
.section .rodata,"a"
.p2align 6
.amdhsa_kernel parallel_sum__sliding_block__dense_activation_gelu__prompt_kernel
  .amdhsa_next_free_vgpr 256
  .amdhsa_next_free_sgpr 102
  .amdhsa_accum_offset 256
  .amdhsa_group_segment_fixed_size 0
  .amdhsa_kernarg_size 88
  .amdhsa_user_sgpr_count 2
  .amdhsa_user_sgpr_kernarg_segment_ptr 1
  .amdhsa_system_sgpr_workgroup_id_x 1
  .amdhsa_float_denorm_mode_32 3
  .amdhsa_float_denorm_mode_16_64 3
.end_amdhsa_kernel
```
